```python
import torch

def _softmax(x, axis=-1):
    return torch.softmax(x, dim=axis)
def _gelu(x):
    return torch.nn.functional.gelu(x, approximate="tanh")
def _silu(x):
    return torch.nn.functional.silu(x)
def _sigmoid(x):
    return torch.sigmoid(x)
def _layernorm(x, axis=-1, eps=1e-5):
    m = x.mean(dim=axis, keepdim=True)
    v = x.var(dim=axis, keepdim=True, unbiased=False)
    return (x - m) / torch.sqrt(v + eps)
def _scatter_add(tgt, idx, src, axis=0):
    return tgt.clone().index_add_(axis, idx, src)
def _segment_sum(src, seg, n):
    out = torch.zeros((n,) + src.shape[1:], dtype=src.dtype)
    return out.index_add_(0, seg, src)
def _pad(x, pw):
    flat = tuple(v for pair in reversed(pw) for v in pair)
    return torch.nn.functional.pad(x, flat)

kernel_name = 'standalone__edge_featured_mpnn_gatedgcn__graph'

def setup_inputs():

    _w = (lambda a: (lambda t: t.to(torch.bfloat16) if t.is_floating_point() else t)(torch.as_tensor(a)))
    N, deg, D, De = 12500, 64, 64, max(4, 1)
    E = N * deg
    return {
        "x": _w((lambda *s: torch.randn(*s, dtype=torch.bfloat16) * 0.8)(N, D)),
        "e_attr": _w((lambda *s: torch.randn(*s, dtype=torch.bfloat16) * 0.8)(E, De)),
        "src": _w((lambda lo, hi, *s: torch.randint(lo, hi, s))(0, N, E).to(torch.int64)),
        "dst": _w((lambda lo, hi, *s: torch.randint(lo, hi, s))(0, N, E).to(torch.int64)),
        "w_a": _w((lambda *s: torch.randn(*s, dtype=torch.bfloat16) * 0.8)(D, D)),
        "w_b": _w((lambda *s: torch.randn(*s, dtype=torch.bfloat16) * 0.8)(D, D)),
        "w_c": _w((lambda *s: torch.randn(*s, dtype=torch.bfloat16) * 0.8)(De, D)),
        "w_u": _w((lambda *s: torch.randn(*s, dtype=torch.bfloat16) * 0.05)(D, D)),
        "w_v": _w((lambda *s: torch.randn(*s, dtype=torch.bfloat16) * 0.05)(D, D)),
    }

def reference(x, e_attr, src, dst, w_a, w_b, w_c, w_u, w_v):
    N, D = x.shape
    hv = x @ w_v
    g = x[dst] @ w_a + x[src] @ w_b + e_attr @ w_c
    eta = _sigmoid(g)
    denom = _segment_sum(eta, dst, N) + 1e-6
    eta_n = eta / denom[dst]
    agg = _segment_sum(eta_n * hv[src], dst, N)
    z = x @ w_u + agg
    relu_z = torch.where(z > 0, z, 0 * z)
    return x + relu_z
```

```asm
; @launch kernel=bin_kernel grid=(252,1,1) block=(1024,1,1) lds=87552
; @launch kernel=standalone__edge_featured_mpnn_gatedgcn__graph_kernel grid=(256,1,1) block=(1024,1,1) lds=144640
.amdgcn_target "amdgcn-amd-amdhsa--gfx950"
.text
.globl bin_kernel
.p2align 8
.type bin_kernel,@function
bin_kernel:
    s_cmp_ge_u32 s2, 252
    s_cbranch_scc1 K1_end
    s_cmp_ge_u32 s2, 250
    s_cbranch_scc1 K1_weights
    v_lshrrev_b32 v1, 6, v0
    s_load_dwordx2 s[12:13], s[0:1], 24
    s_load_dwordx4 s[4:7], s[0:1], 8
    s_load_dwordx2 s[16:17], s[0:1], 88
    v_readfirstlane_b32 s28, v1
    s_nop 1
    s_cmp_ge_u32 s28, 13
    s_cbranch_scc1 K1_ptab
    v_lshlrev_b32 v1, 2, v0
    v_mov_b32 v2, 0
    v_mov_b32 v40, 1
    s_mul_i32 s3, s2, 12800
    v_lshl_add_u32 v3, v0, 4, s3
    v_lshlrev_b32 v4, 1, v3
    v_cmp_gt_u32 vcc, 256, v0
    s_and_saveexec_b64 s[30:31], vcc
    ds_write_b32 v1, v2 offset:38400
    s_mov_b64 exec, s[30:31]
    s_movk_i32 s34, 800
    v_cmp_gt_u32 s[32:33], s34, v0
    s_waitcnt lgkmcnt(0)
    s_and_b32 s13, s13, 0xffff
    s_mov_b32 s14, 3200000
    s_mov_b32 s15, 0x20000
    s_mov_b64 exec, s[32:33]
    buffer_load_dwordx4 v[8:11], v3, s[12:15], 0 offen
    s_mov_b32 s8, s6
    s_and_b32 s9, s7, 0xffff
    s_mov_b32 s10, 3200000
    s_mov_b32 s11, 0x20000
    s_and_b32 s5, s5, 0xffff
    s_mov_b32 s6, 6400000
    s_mov_b32 s7, 0x20000
    s_barrier
    buffer_load_dwordx4 v[12:15], v3, s[8:11], 0 offen
    buffer_load_dwordx4 v[16:19], v4, s[4:7], 0 offen
    buffer_load_dwordx4 v[20:23], v4, s[4:7], 0 offen offset:16
    s_and_b32 s17, s17, 0xffff
    s_mov_b32 s18, 9600000
    s_mov_b32 s19, 0x20000
    s_movk_i32 s35, 21400
    s_movk_i32 s36, -196
    s_waitcnt vmcnt(3)
    v_mul_u32_u24 v24, s35, v8
    v_lshrrev_b32 v24, 20, v24
    v_lshlrev_b32 v8, 2, v8
    v_mad_i32_i24 v8, v24, s36, v8
    v_lshlrev_b32 v24, 2, v24
    ds_add_rtn_u32 v28, v24, v40 offset:38400
    v_mul_u32_u24 v25, s35, v9
    v_lshrrev_b32 v25, 20, v25
    v_lshlrev_b32 v9, 2, v9
    v_mad_i32_i24 v9, v25, s36, v9
    v_lshlrev_b32 v25, 2, v25
    ds_add_rtn_u32 v29, v25, v40 offset:38400
    v_mul_u32_u24 v26, s35, v10
    v_lshrrev_b32 v26, 20, v26
    v_lshlrev_b32 v10, 2, v10
    v_mad_i32_i24 v10, v26, s36, v10
    v_lshlrev_b32 v26, 2, v26
    ds_add_rtn_u32 v30, v26, v40 offset:38400
    v_mul_u32_u24 v27, s35, v11
    v_lshrrev_b32 v27, 20, v27
    v_lshlrev_b32 v11, 2, v11
    v_mad_i32_i24 v11, v27, s36, v11
    v_lshlrev_b32 v27, 2, v27
    ds_add_rtn_u32 v31, v27, v40 offset:38400
    s_mov_b64 exec, -1
    v_and_b32 v5, 63, v0
    v_lshlrev_b32 v5, 4, v5
    v_lshlrev_b32 v6, 4, v0
    s_waitcnt lgkmcnt(0)
    s_barrier
    ds_read_b128 v[32:35], v5 offset:38400
    s_waitcnt lgkmcnt(0)
    v_add_u32 v37, v32, v33
    v_add_u32 v38, v37, v34
    v_add_u32 v39, v38, v35
    v_mov_b32 v41, v39
    s_nop 1
    v_add_u32_dpp v41, v41, v41 row_shr:1 row_mask:0xf bank_mask:0xf bound_ctrl:0
    s_nop 1
    v_add_u32_dpp v41, v41, v41 row_shr:2 row_mask:0xf bank_mask:0xf bound_ctrl:0
    s_nop 1
    v_add_u32_dpp v41, v41, v41 row_shr:4 row_mask:0xf bank_mask:0xf bound_ctrl:0
    s_nop 1
    v_add_u32_dpp v41, v41, v41 row_shr:8 row_mask:0xf bank_mask:0xf bound_ctrl:0
    s_nop 1
    v_add_u32_dpp v41, v41, v41 row_bcast:15 row_mask:0xa bank_mask:0xf
    s_nop 1
    v_add_u32_dpp v41, v41, v41 row_bcast:31 row_mask:0xc bank_mask:0xf
    v_sub_u32 v44, v41, v39
    v_add_u32 v45, v44, v32
    v_add_u32 v46, v44, v37
    v_add_u32 v47, v44, v38
    ds_write_b128 v5, v[44:47] offset:39424
    s_mov_b64 exec, s[32:33]
    ds_read_b32 v24, v24 offset:39424
    ds_read_b32 v25, v25 offset:39424
    ds_read_b32 v26, v26 offset:39424
    ds_read_b32 v27, v27 offset:39424
    s_waitcnt lgkmcnt(0)
    v_add_u32 v24, v24, v28
    v_mul_u32_u24 v24, 12, v24
    v_add_u32 v25, v25, v29
    v_mul_u32_u24 v25, 12, v25
    v_add_u32 v26, v26, v30
    v_mul_u32_u24 v26, 12, v26
    v_add_u32 v27, v27, v31
    v_mul_u32_u24 v27, 12, v27
    s_waitcnt vmcnt(2)
    v_lshl_or_b32 v8, v12, 8, v8
    ds_write_b32 v24, v8 offset:8
    v_lshl_or_b32 v9, v13, 8, v9
    ds_write_b32 v25, v9 offset:8
    v_lshl_or_b32 v10, v14, 8, v10
    ds_write_b32 v26, v10 offset:8
    v_lshl_or_b32 v11, v15, 8, v11
    ds_write_b32 v27, v11 offset:8
    s_waitcnt vmcnt(0)
    ds_write2_b32 v24, v16, v17 offset0:0 offset1:1
    ds_write2_b32 v25, v18, v19 offset0:0 offset1:1
    ds_write2_b32 v26, v20, v21 offset0:0 offset1:1
    ds_write2_b32 v27, v22, v23 offset0:0 offset1:1
    s_mul_i32 s3, s2, 38400
    s_add_u32 s37, s3, 12800
    s_add_u32 s38, s3, 25600
    s_waitcnt lgkmcnt(0)
    s_barrier
    ds_read_b128 v[8:11], v6
    ds_read_b128 v[12:15], v6 offset:12800
    ds_read_b128 v[16:19], v6 offset:25600
    s_waitcnt lgkmcnt(2)
    buffer_store_dwordx4 v[8:11], v6, s[16:19], s3 offen sc0 sc1
    s_waitcnt lgkmcnt(1)
    buffer_store_dwordx4 v[12:15], v6, s[16:19], s37 offen sc0 sc1
    s_waitcnt lgkmcnt(0)
    buffer_store_dwordx4 v[16:19], v6, s[16:19], s38 offen sc0 sc1
    s_endpgm
K1_ptab:
    s_load_dwordx2 s[44:45], s[0:1], 0
    s_load_dwordx2 s[8:9], s[0:1], 40
    s_load_dwordx2 s[46:47], s[0:1], 64
    s_sub_u32 s28, s28, 13
    v_and_b32 v1, 63, v0
    s_mul_i32 s29, s2, 50
    s_mul_i32 s31, s28, 17
    s_add_u32 s30, s31, 17
    s_min_u32 s30, s30, 50
    s_add_u32 s30, s30, s29
    s_add_u32 s31, s31, s29
    v_lshrrev_b32 v2, 3, v1
    v_add_u32 v2, s31, v2
    v_lshlrev_b32 v2, 7, v2
    v_and_b32 v3, 7, v1
    v_lshrrev_b32 v4, 4, v1
    v_xor_b32 v3, v3, v4
    v_lshl_add_u32 v2, v3, 4, v2
    v_xor_b32 v3, 64, v2
    v_add_u32 v3, 1024, v3
    v_add_u32 v5, 2048, v2
    v_lshrrev_b32 v7, 2, v1
    v_lshlrev_b32 v7, 7, v7
    v_and_b32 v8, 3, v1
    v_lshl_add_u32 v7, v8, 4, v7
    v_add_u32 v8, 64, v7
    s_lshl_b32 s33, s28, 12
    s_add_u32 s33, s33, 40448
    s_lshl_b32 s32, s30, 7
    s_movk_i32 s35, 2048
    s_movk_i32 s36, 4096
    s_movk_i32 s37, 6144
    s_waitcnt lgkmcnt(0)
    s_mov_b32 s4, s44
    s_and_b32 s5, s45, 0xffff
    s_mov_b32 s6, s32
    s_mov_b32 s7, 0x20000
    s_and_b32 s9, s9, 0xffff
    s_mov_b32 s10, 8192
    s_mov_b32 s11, 0x20000
    s_mov_b32 s12, s46
    s_and_b32 s13, s47, 0xffff
    s_mov_b32 s14, 8192
    s_mov_b32 s15, 0x20000
    s_mov_b32 m0, s33
    s_nop 0
    buffer_load_dwordx4 v2, s[4:7], 0 offen lds
    s_add_u32 m0, m0, 1024
    s_nop 0
    buffer_load_dwordx4 v3, s[4:7], 0 offen lds
    s_add_u32 m0, m0, 1024
    s_nop 0
    buffer_load_dwordx4 v5, s[4:7], 0 offen lds
    s_add_u32 m0, m0, 1024
    s_cmp_lg_u32 s28, 0
    s_cbranch_scc1 K1_wd1
    s_mov_b32 m0, 52736
    s_nop 0
    buffer_load_dwordx4 v7, s[8:11], 0 offen lds
    s_mov_b32 m0, 55808
    s_nop 0
    buffer_load_dwordx4 v7, s[8:11], s37 offen lds
    s_mov_b32 m0, 58880
    s_nop 0
    buffer_load_dwordx4 v8, s[8:11], s36 offen lds
    s_mov_b32 m0, 61952
    s_nop 0
    buffer_load_dwordx4 v7, s[12:15], s35 offen lds
    s_mov_b32 m0, 65024
    s_nop 0
    buffer_load_dwordx4 v8, s[12:15], 0 offen lds
    s_mov_b32 m0, 68096
    s_nop 0
    buffer_load_dwordx4 v8, s[12:15], s37 offen lds
    s_branch K1_pt1
K1_wd1:
    s_cmp_lg_u32 s28, 1
    s_cbranch_scc1 K1_wd2
    s_mov_b32 m0, 53760
    s_nop 0
    buffer_load_dwordx4 v7, s[8:11], s35 offen lds
    s_mov_b32 m0, 56832
    s_nop 0
    buffer_load_dwordx4 v8, s[8:11], 0 offen lds
    s_mov_b32 m0, 59904
    s_nop 0
    buffer_load_dwordx4 v8, s[8:11], s37 offen lds
    s_mov_b32 m0, 62976
    s_nop 0
    buffer_load_dwordx4 v7, s[12:15], s36 offen lds
    s_mov_b32 m0, 66048
    s_nop 0
    buffer_load_dwordx4 v8, s[12:15], s35 offen lds
    s_branch K1_pt1
K1_wd2:
    s_mov_b32 m0, 54784
    s_nop 0
    buffer_load_dwordx4 v7, s[8:11], s36 offen lds
    s_mov_b32 m0, 57856
    s_nop 0
    buffer_load_dwordx4 v8, s[8:11], s35 offen lds
    s_mov_b32 m0, 60928
    s_nop 0
    buffer_load_dwordx4 v7, s[12:15], 0 offen lds
    s_mov_b32 m0, 64000
    s_nop 0
    buffer_load_dwordx4 v7, s[12:15], s37 offen lds
    s_mov_b32 m0, 67072
    s_nop 0
    buffer_load_dwordx4 v8, s[12:15], s36 offen lds
K1_pt1:
    s_barrier
    v_and_b32 v9, 31, v1
    v_lshrrev_b32 v10, 5, v1
    v_bfe_u32 v11, v9, 1, 3
    v_xor_b32 v11, v11, v10
    v_lshlrev_b32 v11, 4, v11
    v_lshl_add_u32 v11, v9, 7, v11
    v_xor_b32 v12, 0, v11
    v_add_u32 v12, s33, v12
    v_xor_b32 v13, 32, v11
    v_add_u32 v13, s33, v13
    v_xor_b32 v14, 64, v11
    v_add_u32 v14, s33, v14
    v_xor_b32 v15, 96, v11
    v_add_u32 v15, s33, v15
    v_bfe_u32 v16, v1, 2, 2
    v_lshl_add_u32 v16, v10, 3, v16
    v_lshlrev_b32 v16, 6, v16
    v_bfe_u32 v17, v1, 4, 1
    v_lshl_add_u32 v16, v17, 5, v16
    v_and_b32 v17, 3, v1
    v_lshl_add_u32 v16, v17, 3, v16
    v_add_u32 v16, 52736, v16
    s_mul_i32 s34, s28, 6144
    s_add_u32 s34, s34, 69120
    v_lshlrev_b32 v18, 10, v10
    v_lshl_add_u32 v18, v9, 2, v18
    v_add_u32 v18, s34, v18
    v_lshlrev_b32 v5, 4, v1
    v_add_u32 v3, s34, v5
    s_lshl_b32 s31, s31, 8
    v_add_u32 v2, s31, v5
    s_add_u32 s20, s16, 9600000
    s_addc_u32 s21, s17, 0
    s_add_u32 s16, s16, 9873408
    s_addc_u32 s17, s17, 0
    s_and_b32 s21, s21, 0xffff
    s_mov_b32 s22, 256000
    s_mov_b32 s23, 0x20000
    s_lshl_b32 s30, s30, 8
    s_and_b32 s17, s17, 0xffff
    s_mov_b32 s18, s30
    s_mov_b32 s19, 0x20000
    s_mov_b32 s38, 0xbfb8aa3b
    s_mov_b32 s39, 0x7fff0000
    s_brev_b32 s40, 1
    s_waitcnt vmcnt(0)
    ds_read_b128 v[20:23], v12
    ds_read_b128 v[24:27], v13
    ds_read_b128 v[28:31], v14
    ds_read_b128 v[32:35], v15
    s_barrier
    ds_read_b64_tr_b16 v[36:37], v16 offset:0
    ds_read_b64_tr_b16 v[38:39], v16 offset:256
    ds_read_b64_tr_b16 v[40:41], v16 offset:1024
    ds_read_b64_tr_b16 v[42:43], v16 offset:1280
    ds_read_b64_tr_b16 v[44:45], v16 offset:2048
    ds_read_b64_tr_b16 v[46:47], v16 offset:2304
    ds_read_b64_tr_b16 v[48:49], v16 offset:3072
    ds_read_b64_tr_b16 v[50:51], v16 offset:3328
    s_waitcnt lgkmcnt(4)
    ds_read_b64_tr_b16 v[52:53], v16 offset:8192
    ds_read_b64_tr_b16 v[54:55], v16 offset:8448
    ds_read_b64_tr_b16 v[56:57], v16 offset:9216
    ds_read_b64_tr_b16 v[58:59], v16 offset:9472
    ds_read_b64_tr_b16 v[60:61], v16 offset:10240
    ds_read_b64_tr_b16 v[62:63], v16 offset:10496
    ds_read_b64_tr_b16 v[64:65], v16 offset:11264
    ds_read_b64_tr_b16 v[66:67], v16 offset:11520
    s_cmp_lg_u32 s28, 2
    s_cbranch_scc1 K1_ptx
    ds_read_b128 v[68:71], v5 offset:38400
    s_waitcnt lgkmcnt(0)
    v_add_u32 v73, v68, v69
    v_add_u32 v74, v73, v70
    v_add_u32 v75, v74, v71
    v_mov_b32 v76, v75
    s_nop 1
    v_add_u32_dpp v76, v76, v76 row_shr:1 row_mask:0xf bank_mask:0xf bound_ctrl:0
    s_nop 1
    v_add_u32_dpp v76, v76, v76 row_shr:2 row_mask:0xf bank_mask:0xf bound_ctrl:0
    s_nop 1
    v_add_u32_dpp v76, v76, v76 row_shr:4 row_mask:0xf bank_mask:0xf bound_ctrl:0
    s_nop 1
    v_add_u32_dpp v76, v76, v76 row_shr:8 row_mask:0xf bank_mask:0xf bound_ctrl:0
    s_nop 1
    v_add_u32_dpp v76, v76, v76 row_bcast:15 row_mask:0xa bank_mask:0xf
    s_nop 1
    v_add_u32_dpp v76, v76, v76 row_bcast:31 row_mask:0xc bank_mask:0xf
    v_sub_u32 v108, v76, v75
    v_add_u32 v109, v108, v68
    v_add_u32 v110, v108, v73
    v_add_u32 v111, v108, v74
    v_lshl_or_b32 v108, v68, 16, v108
    v_lshl_or_b32 v109, v69, 16, v109
    v_lshl_or_b32 v110, v70, 16, v110
    v_lshl_or_b32 v111, v71, 16, v111
    s_lshl_b32 s3, s2, 10
    v_add_u32 v5, s3, v5
    buffer_store_dwordx4 v[108:111], v5, s[20:23], 0 offen sc0 sc1
K1_ptx:
    s_waitcnt lgkmcnt(8)
    v_mfma_f32_32x32x16_bf16 v[68:83], v[20:23], v[36:39], 0
    v_mfma_f32_32x32x16_bf16 v[68:83], v[24:27], v[40:43], v[68:83]
    v_mfma_f32_32x32x16_bf16 v[68:83], v[28:31], v[44:47], v[68:83]
    v_mfma_f32_32x32x16_bf16 v[68:83], v[32:35], v[48:51], v[68:83]
    s_waitcnt lgkmcnt(0)
    v_mfma_f32_32x32x16_bf16 v[92:107], v[20:23], v[52:55], 0
    v_mfma_f32_32x32x16_bf16 v[92:107], v[24:27], v[56:59], v[92:107]
    v_mfma_f32_32x32x16_bf16 v[92:107], v[28:31], v[60:63], v[92:107]
    v_mfma_f32_32x32x16_bf16 v[92:107], v[32:35], v[64:67], v[92:107]
    ds_read_b64_tr_b16 v[36:37], v16 offset:4096
    ds_read_b64_tr_b16 v[38:39], v16 offset:4352
    ds_read_b64_tr_b16 v[40:41], v16 offset:5120
    ds_read_b64_tr_b16 v[42:43], v16 offset:5376
    ds_read_b64_tr_b16 v[44:45], v16 offset:6144
    ds_read_b64_tr_b16 v[46:47], v16 offset:6400
    ds_read_b64_tr_b16 v[48:49], v16 offset:7168
    ds_read_b64_tr_b16 v[50:51], v16 offset:7424
    s_waitcnt lgkmcnt(4)
    ds_read_b64_tr_b16 v[52:53], v16 offset:12288
    ds_read_b64_tr_b16 v[54:55], v16 offset:12544
    ds_read_b64_tr_b16 v[56:57], v16 offset:13312
    ds_read_b64_tr_b16 v[58:59], v16 offset:13568
    ds_read_b64_tr_b16 v[60:61], v16 offset:14336
    ds_read_b64_tr_b16 v[62:63], v16 offset:14592
    ds_read_b64_tr_b16 v[64:65], v16 offset:15360
    ds_read_b64_tr_b16 v[66:67], v16 offset:15616
    s_nop 3
    v_mul_f32 v68, s38, v68
    v_mul_f32 v69, s38, v69
    v_mul_f32 v70, s38, v70
    v_mul_f32 v71, s38, v71
    v_mul_f32 v72, s38, v72
    v_mul_f32 v73, s38, v73
    v_mul_f32 v74, s38, v74
    v_mul_f32 v75, s38, v75
    v_mul_f32 v76, s38, v76
    v_cvt_pk_bf16_f32 v68, v68, 0
    v_cvt_pk_bf16_f32 v69, v69, 0
    v_cvt_pk_bf16_f32 v70, v70, 0
    v_cvt_pk_bf16_f32 v71, v71, 0
    v_cvt_pk_bf16_f32 v72, v72, 0
    v_cvt_pk_bf16_f32 v73, v73, 0
    v_cvt_pk_bf16_f32 v74, v74, 0
    v_cvt_pk_bf16_f32 v75, v75, 0
    v_cvt_pk_bf16_f32 v76, v76, 0
    v_and_b32 v108, 0x7fffffff, v92
    v_add_u32 v108, 0x8000, v108
    v_sub_u32_e64 v108, v108, v68 clamp
    v_and_or_b32 v108, v108, s39, v68
    v_bfi_b32 v108, s40, v92, v108
    ds_write_b32 v18, v108 offset:0
    v_and_b32 v109, 0x7fffffff, v93
    v_add_u32 v109, 0x8000, v109
    v_sub_u32_e64 v109, v109, v69 clamp
    v_and_or_b32 v109, v109, s39, v69
    v_bfi_b32 v109, s40, v93, v109
    ds_write_b32 v18, v109 offset:256
    v_and_b32 v110, 0x7fffffff, v94
    v_add_u32 v110, 0x8000, v110
    v_sub_u32_e64 v110, v110, v70 clamp
    v_and_or_b32 v110, v110, s39, v70
    v_bfi_b32 v110, s40, v94, v110
    ds_write_b32 v18, v110 offset:512
    v_and_b32 v111, 0x7fffffff, v95
    v_add_u32 v111, 0x8000, v111
    v_sub_u32_e64 v111, v111, v71 clamp
    v_and_or_b32 v111, v111, s39, v71
    v_bfi_b32 v111, s40, v95, v111
    ds_write_b32 v18, v111 offset:768
    v_and_b32 v112, 0x7fffffff, v96
    v_add_u32 v112, 0x8000, v112
    v_sub_u32_e64 v112, v112, v72 clamp
    v_and_or_b32 v112, v112, s39, v72
    v_bfi_b32 v112, s40, v96, v112
    ds_write_b32 v18, v112 offset:2048
    v_and_b32 v113, 0x7fffffff, v97
    v_add_u32 v113, 0x8000, v113
    v_sub_u32_e64 v113, v113, v73 clamp
    v_and_or_b32 v113, v113, s39, v73
    v_bfi_b32 v113, s40, v97, v113
    ds_write_b32 v18, v113 offset:2304
    v_and_b32 v114, 0x7fffffff, v98
    v_add_u32 v114, 0x8000, v114
    v_sub_u32_e64 v114, v114, v74 clamp
    v_and_or_b32 v114, v114, s39, v74
    v_bfi_b32 v114, s40, v98, v114
    ds_write_b32 v18, v114 offset:2560
    v_and_b32 v115, 0x7fffffff, v99
    v_add_u32 v115, 0x8000, v115
    v_sub_u32_e64 v115, v115, v75 clamp
    v_and_or_b32 v115, v115, s39, v75
    v_bfi_b32 v115, s40, v99, v115
    ds_write_b32 v18, v115 offset:2816
    v_and_b32 v116, 0x7fffffff, v100
    v_add_u32 v116, 0x8000, v116
    v_sub_u32_e64 v116, v116, v76 clamp
    v_and_or_b32 v116, v116, s39, v76
    v_bfi_b32 v116, s40, v100, v116
    ds_write_b32 v18, v116 offset:4096
    s_waitcnt lgkmcnt(8)
    v_mfma_f32_32x32x16_bf16 v[68:83], v[20:23], v[36:39], 0
    v_mfma_f32_32x32x16_bf16 v[68:83], v[24:27], v[40:43], v[68:83]
    v_mfma_f32_32x32x16_bf16 v[68:83], v[28:31], v[44:47], v[68:83]
    v_mfma_f32_32x32x16_bf16 v[68:83], v[32:35], v[48:51], v[68:83]
    s_waitcnt lgkmcnt(0)
    v_mfma_f32_32x32x16_bf16 v[92:107], v[20:23], v[52:55], 0
    v_mfma_f32_32x32x16_bf16 v[92:107], v[24:27], v[56:59], v[92:107]
    v_mfma_f32_32x32x16_bf16 v[92:107], v[28:31], v[60:63], v[92:107]
    v_mfma_f32_32x32x16_bf16 v[92:107], v[32:35], v[64:67], v[92:107]
    s_nop 7
    v_mul_f32 v68, s38, v68
    v_mul_f32 v69, s38, v69
    v_mul_f32 v70, s38, v70
    v_mul_f32 v71, s38, v71
    v_mul_f32 v72, s38, v72
    v_mul_f32 v73, s38, v73
    v_mul_f32 v74, s38, v74
    v_mul_f32 v75, s38, v75
    v_mul_f32 v76, s38, v76
    v_cvt_pk_bf16_f32 v68, v68, 0
    v_cvt_pk_bf16_f32 v69, v69, 0
    v_cvt_pk_bf16_f32 v70, v70, 0
    v_cvt_pk_bf16_f32 v71, v71, 0
    v_cvt_pk_bf16_f32 v72, v72, 0
    v_cvt_pk_bf16_f32 v73, v73, 0
    v_cvt_pk_bf16_f32 v74, v74, 0
    v_cvt_pk_bf16_f32 v75, v75, 0
    v_cvt_pk_bf16_f32 v76, v76, 0
    v_and_b32 v108, 0x7fffffff, v92
    v_add_u32 v108, 0x8000, v108
    v_sub_u32_e64 v108, v108, v68 clamp
    v_and_or_b32 v108, v108, s39, v68
    v_bfi_b32 v108, s40, v92, v108
    ds_write_b32 v18, v108 offset:128
    v_and_b32 v109, 0x7fffffff, v93
    v_add_u32 v109, 0x8000, v109
    v_sub_u32_e64 v109, v109, v69 clamp
    v_and_or_b32 v109, v109, s39, v69
    v_bfi_b32 v109, s40, v93, v109
    ds_write_b32 v18, v109 offset:384
    v_and_b32 v110, 0x7fffffff, v94
    v_add_u32 v110, 0x8000, v110
    v_sub_u32_e64 v110, v110, v70 clamp
    v_and_or_b32 v110, v110, s39, v70
    v_bfi_b32 v110, s40, v94, v110
    ds_write_b32 v18, v110 offset:640
    v_and_b32 v111, 0x7fffffff, v95
    v_add_u32 v111, 0x8000, v111
    v_sub_u32_e64 v111, v111, v71 clamp
    v_and_or_b32 v111, v111, s39, v71
    v_bfi_b32 v111, s40, v95, v111
    ds_write_b32 v18, v111 offset:896
    v_and_b32 v112, 0x7fffffff, v96
    v_add_u32 v112, 0x8000, v112
    v_sub_u32_e64 v112, v112, v72 clamp
    v_and_or_b32 v112, v112, s39, v72
    v_bfi_b32 v112, s40, v96, v112
    ds_write_b32 v18, v112 offset:2176
    v_and_b32 v113, 0x7fffffff, v97
    v_add_u32 v113, 0x8000, v113
    v_sub_u32_e64 v113, v113, v73 clamp
    v_and_or_b32 v113, v113, s39, v73
    v_bfi_b32 v113, s40, v97, v113
    ds_write_b32 v18, v113 offset:2432
    v_and_b32 v114, 0x7fffffff, v98
    v_add_u32 v114, 0x8000, v114
    v_sub_u32_e64 v114, v114, v74 clamp
    v_and_or_b32 v114, v114, s39, v74
    v_bfi_b32 v114, s40, v98, v114
    ds_write_b32 v18, v114 offset:2688
    v_and_b32 v115, 0x7fffffff, v99
    v_add_u32 v115, 0x8000, v115
    v_sub_u32_e64 v115, v115, v75 clamp
    v_and_or_b32 v115, v115, s39, v75
    v_bfi_b32 v115, s40, v99, v115
    ds_write_b32 v18, v115 offset:2944
    v_and_b32 v116, 0x7fffffff, v100
    v_add_u32 v116, 0x8000, v116
    v_sub_u32_e64 v116, v116, v76 clamp
    v_and_or_b32 v116, v116, s39, v76
    v_bfi_b32 v116, s40, v100, v116
    ds_write_b32 v18, v116 offset:4224
    ds_read_b128 v[20:23], v3 offset:0
    ds_read_b128 v[24:27], v3 offset:1024
    ds_read_b128 v[28:31], v3 offset:2048
    ds_read_b128 v[32:35], v3 offset:3072
    ds_read_b128 v[36:39], v3 offset:4096
    s_waitcnt lgkmcnt(4)
    buffer_store_dwordx4 v[20:23], v2, s[16:19], 0 offen sc0 sc1
    v_add_u32 v2, 1024, v2
    s_waitcnt lgkmcnt(3)
    buffer_store_dwordx4 v[24:27], v2, s[16:19], 0 offen sc0 sc1
    v_add_u32 v2, 1024, v2
    s_waitcnt lgkmcnt(2)
    buffer_store_dwordx4 v[28:31], v2, s[16:19], 0 offen sc0 sc1
    v_add_u32 v2, 1024, v2
    s_waitcnt lgkmcnt(1)
    buffer_store_dwordx4 v[32:35], v2, s[16:19], 0 offen sc0 sc1
    v_add_u32 v2, 1024, v2
    s_waitcnt lgkmcnt(0)
    buffer_store_dwordx4 v[36:39], v2, s[16:19], 0 offen sc0 sc1
    s_barrier
    s_endpgm
K1_weights:
    s_sub_u32 s3, s2, 250
    s_cmp_eq_u32 s3, 0
    s_cselect_b32 s24, 32, 56
    s_load_dwordx2 s[4:5], s[0:1], s24
    s_load_dwordx2 s[8:9], s[0:1], 48
    s_load_dwordx2 s[16:17], s[0:1], 88
    v_and_b32 v1, 31, v0
    v_bfe_u32 v2, v0, 5, 1
    v_bfe_u32 v3, v0, 6, 2
    v_bfe_u32 v4, v0, 8, 1
    v_lshl_add_u32 v5, v3, 1, v2
    v_lshlrev_b32 v5, 10, v5
    v_lshl_add_u32 v6, v4, 5, v1
    v_lshl_add_u32 v5, v6, 1, v5
    s_waitcnt lgkmcnt(0)
    s_and_b32 s5, s5, 0xffff
    s_mov_b32 s6, 8192
    s_mov_b32 s7, 0x20000
    s_and_b32 s9, s9, 0xffff
    s_mov_b32 s10, 512
    s_mov_b32 s11, 0x20000
    s_add_u32 s16, s16, 9856000
    s_addc_u32 s17, s17, 0
    s_and_b32 s17, s17, 0xffff
    s_mov_b32 s18, 3217664
    s_mov_b32 s19, 0x20000
    s_movk_i32 s34, 512
    v_cmp_gt_u32 vcc, s34, v0
    s_and_saveexec_b64 s[30:31], vcc
    s_cbranch_execz K1_wc
    buffer_load_ushort v8, v5, s[4:7], 0 offen offset:0
    buffer_load_ushort v9, v5, s[4:7], 0 offen offset:128
    buffer_load_ushort v10, v5, s[4:7], 0 offen offset:256
    buffer_load_ushort v11, v5, s[4:7], 0 offen offset:384
    buffer_load_ushort v12, v5, s[4:7], 0 offen offset:512
    buffer_load_ushort v13, v5, s[4:7], 0 offen offset:640
    buffer_load_ushort v14, v5, s[4:7], 0 offen offset:768
    buffer_load_ushort v15, v5, s[4:7], 0 offen offset:896
    s_lshl_b32 s26, s3, 13
    v_lshl_add_u32 v7, v0, 4, s26
    s_waitcnt vmcnt(0)
    v_lshl_or_b32 v16, v9, 16, v8
    v_lshl_or_b32 v17, v11, 16, v10
    v_lshl_or_b32 v18, v13, 16, v12
    v_lshl_or_b32 v19, v15, 16, v14
    buffer_store_dwordx4 v[16:19], v7, s[16:19], 0 offen
    s_endpgm
K1_wc:
    s_mov_b64 exec, s[30:31]
    s_cmp_lg_u32 s3, 0
    s_cbranch_scc1 K1_end
    s_movk_i32 s34, 576
    v_cmp_gt_u32 vcc, s34, v0
    s_and_saveexec_b64 s[30:31], vcc
    s_cbranch_execz K1_end
    v_and_b32 v6, 63, v0
    v_lshlrev_b32 v7, 1, v6
    buffer_load_ushort v8, v7, s[8:11], 0 offen offset:0
    buffer_load_ushort v9, v7, s[8:11], 0 offen offset:128
    buffer_load_ushort v10, v7, s[8:11], 0 offen offset:256
    buffer_load_ushort v11, v7, s[8:11], 0 offen offset:384
    v_lshlrev_b32 v7, 3, v6
    v_add_u32 v7, 16384, v7
    v_lshlrev_b32 v12, 2, v6
    v_add_u32 v12, 3217408, v12
    v_mov_b32 v13, 0x7e00
    buffer_store_dword v13, v12, s[16:19], 0 offen
    s_mov_b32 s25, 0xbfb8aa3b
    s_waitcnt vmcnt(0)
    v_lshlrev_b32 v8, 16, v8
    v_mul_f32 v8, s25, v8
    v_lshlrev_b32 v9, 16, v9
    v_mul_f32 v9, s25, v9
    v_lshlrev_b32 v10, 16, v10
    v_mul_f32 v10, s25, v10
    v_lshlrev_b32 v11, 16, v11
    v_mul_f32 v11, s25, v11
    v_cvt_pk_bf16_f32 v16, v8, v9
    v_cvt_pk_bf16_f32 v17, v10, v11
    buffer_store_dwordx2 v[16:17], v7, s[16:19], 0 offen
K1_end:
    s_endpgm
.globl standalone__edge_featured_mpnn_gatedgcn__graph_kernel
.p2align 8
.type standalone__edge_featured_mpnn_gatedgcn__graph_kernel,@function
standalone__edge_featured_mpnn_gatedgcn__graph_kernel:
    s_cmp_ge_u32 s2, 256
    s_cbranch_scc1 K2_end
    s_and_b32 s3, s2, 7
    s_lshr_b32 s2, s2, 3
    s_lshl_b32 s3, s3, 5
    s_or_b32 s2, s2, s3
    s_load_dwordx2 s[16:17], s[0:1], 88
    s_load_dwordx2 s[8:9], s[0:1], 0
    s_load_dwordx2 s[24:25], s[0:1], 72
    v_mov_b32 v91, v0
    v_and_b32 v92, 63, v0
    v_lshrrev_b32 v1, 6, v0
    v_lshrrev_b32 v3, 4, v0
    v_readfirstlane_b32 s28, v1
    v_and_b32 v5, 3, v0
    v_lshl_add_u32 v4, v3, 2, v5
    s_lshl_b32 s3, s2, 2
    v_lshl_add_u32 v4, v4, 10, s3
    s_mov_b32 s64, 153600
    v_mul_lo_u32 v93, v3, s64
    s_mul_i32 s65, s2, 49
    s_add_u32 s66, s65, 49
    s_min_u32 s66, s66, 12500
    s_lshl_b32 s66, s66, 7
    v_lshrrev_b32 v6, 3, v0
    v_bfe_u32 v7, v0, 4, 3
    v_and_b32 v8, 7, v0
    v_xor_b32 v7, v7, v8
    v_add_u32 v6, s65, v6
    v_lshlrev_b32 v6, 7, v6
    v_lshl_add_u32 v6, v7, 4, v6
    s_lshl_b32 s67, s28, 10
    s_add_u32 m0, s67, 120064
    s_waitcnt lgkmcnt(0)
    s_add_u32 s12, s16, 9600000
    s_addc_u32 s13, s17, 0
    s_and_b32 s13, s13, 0xffff
    s_mov_b32 s14, 256000
    s_mov_b32 s15, 0x20000
    buffer_load_dword v95, v4, s[12:15], 0 offen
    s_and_b32 s9, s9, 0xffff
    s_mov_b32 s10, s66
    s_mov_b32 s11, 0x20000
    s_add_u32 s20, s16, 9856000
    s_addc_u32 s21, s17, 0
    s_and_b32 s21, s21, 0xffff
    s_mov_b32 s22, 16896
    s_mov_b32 s23, 0x20000
    s_cmp_ge_u32 s28, 8
    s_cbranch_scc1 K2_nox
    buffer_load_dwordx4 v6, s[8:11], 0 offen lds
    s_branch K2_nof
K2_nox:
    s_sub_u32 s67, s28, 8
    s_lshl_b32 s67, s67, 11
    v_lshl_add_u32 v6, v92, 4, s67
    s_add_u32 m0, s67, 128256
    s_nop 0
    buffer_load_dwordx4 v6, s[20:23], 0 offen lds
    buffer_load_dwordx4 v6, s[20:23], 0 offen offset:1024 lds
K2_nof:
    v_lshlrev_b32 v7, 3, v92
    v_add_u32 v7, 16384, v7
    buffer_load_dwordx2 v[76:77], v7, s[20:23], 0 offen
    s_add_u32 s4, s16, 9873408
    s_addc_u32 s5, s17, 0
    s_and_b32 s17, s17, 0xffff
    s_mov_b32 s18, 9600000
    s_mov_b32 s19, 0x20000
    s_and_b32 s25, s25, 0xffff
    s_mov_b32 s26, s66
    s_mov_b32 s27, 0x20000
    s_mov_b32 s37, 38400
    s_mov_b32 s38, 76800
    s_mov_b32 s39, 115200
    s_mov_b32 s32, 0x58800000
    s_mov_b32 s33, 0x58800000
    s_movk_i32 s63, 0x3f80
    s_mov_b32 s29, 0
    s_mov_b32 s62, 1
    v_lshlrev_b32 v86, 2, v92
    v_add_u32 v86, 53504, v86
    v_mov_b32 v16, 0
    v_mov_b32 v17, 0
    v_mov_b32 v18, 0
    v_mov_b32 v19, 0
    v_lshlrev_b32 v20, 4, v91
    v_add_u32 v21, 86272, v20
    s_movk_i32 s64, 800
    v_cmp_gt_u32 vcc, s64, v91
    s_and_saveexec_b64 s[34:35], vcc
    ds_write_b128 v21, v[16:19]
    ds_write_b128 v21, v[16:19] offset:16896
    s_movk_i32 s64, 320
    v_cmp_gt_u32 vcc, s64, v91
    s_and_b64 exec, exec, vcc
    v_lshrrev_b32 v22, 6, v91
    v_cmp_eq_u32 vcc, 2, v22
    v_mov_b32 v23, 0xffff
    v_lshlrev_b32 v20, 2, v91
    v_cndmask_b32 v22, 0, v23, vcc
    ds_write_b32 v20, v22 offset:0
    s_mov_b64 exec, s[34:35]
    s_cmp_lt_u32 s28, 8
    s_cbranch_scc1 K2_w2
    s_waitcnt vmcnt(3)
    s_branch K2_recs
K2_w2:
    s_waitcnt vmcnt(2)
K2_recs:
    v_and_b32 v89, 15, v92
    v_add_u32 v89, s29, v89
    v_add_u32 v90, 16, v89
    v_add_u32 v88, 32, v89
    s_mov_b64 s[56:57], 0
    s_mov_b64 s[58:59], 0
    s_mov_b32 s81, 0
    v_mov_b32_dpp v56, v95 quad_perm:[0,0,0,0] row_mask:0xf bank_mask:0xf
    v_mov_b32_dpp v57, v95 quad_perm:[1,1,1,1] row_mask:0xf bank_mask:0xf
    v_mov_b32_dpp v58, v95 quad_perm:[2,2,2,2] row_mask:0xf bank_mask:0xf
    v_mov_b32_dpp v59, v95 quad_perm:[3,3,3,3] row_mask:0xf bank_mask:0xf
    v_lshrrev_b32 v84, 16, v56
    v_and_b32 v56, 0xffff, v56
    v_cmp_lt_u32 s[48:49], v90, v84
    v_add_u32 v56, v56, v89
    v_cmp_lt_u32 s[40:41], v89, v84
    v_mad_u32_u24 v56, v56, 12, v93
    v_cmp_lt_u32 vcc, v88, v84
    s_or_b64 s[56:57], s[56:57], s[48:49]
    s_mov_b64 exec, s[48:49]
    s_cbranch_execz K2_nl0
    buffer_load_dwordx3 v[96:98], v56, s[16:19], 0 offen offset:192
    s_add_u32 s81, s81, 1
K2_nl0:
    s_mov_b64 exec, -1
    s_or_b64 s[58:59], s[58:59], vcc
    v_lshrrev_b32 v84, 16, v57
    v_and_b32 v57, 0xffff, v57
    v_cmp_lt_u32 s[50:51], v90, v84
    v_add_u32 v57, v57, v89
    v_cmp_lt_u32 s[42:43], v89, v84
    v_mad_u32_u24 v57, v57, 12, v93
    v_cmp_lt_u32 vcc, v88, v84
    s_or_b64 s[56:57], s[56:57], s[50:51]
    s_mov_b64 exec, s[50:51]
    s_cbranch_execz K2_nl1
    buffer_load_dwordx3 v[100:102], v57, s[16:19], s37 offen offset:192
    s_add_u32 s81, s81, 1
K2_nl1:
    s_mov_b64 exec, -1
    s_or_b64 s[58:59], s[58:59], vcc
    v_lshrrev_b32 v84, 16, v58
    v_and_b32 v58, 0xffff, v58
    v_cmp_lt_u32 s[52:53], v90, v84
    v_add_u32 v58, v58, v89
    v_cmp_lt_u32 s[44:45], v89, v84
    v_mad_u32_u24 v58, v58, 12, v93
    v_cmp_lt_u32 vcc, v88, v84
    s_or_b64 s[56:57], s[56:57], s[52:53]
    s_mov_b64 exec, s[52:53]
    s_cbranch_execz K2_nl2
    buffer_load_dwordx3 v[104:106], v58, s[16:19], s38 offen offset:192
    s_add_u32 s81, s81, 1
K2_nl2:
    s_mov_b64 exec, -1
    s_or_b64 s[58:59], s[58:59], vcc
    v_lshrrev_b32 v84, 16, v59
    v_and_b32 v59, 0xffff, v59
    v_cmp_lt_u32 s[54:55], v90, v84
    v_add_u32 v59, v59, v89
    v_cmp_lt_u32 s[46:47], v89, v84
    v_mad_u32_u24 v59, v59, 12, v93
    v_cmp_lt_u32 vcc, v88, v84
    s_or_b64 s[56:57], s[56:57], s[54:55]
    s_mov_b64 exec, s[54:55]
    s_cbranch_execz K2_nl3
    buffer_load_dwordx3 v[108:110], v59, s[16:19], s39 offen offset:192
    s_add_u32 s81, s81, 1
K2_nl3:
    s_mov_b64 exec, -1
    s_or_b64 s[58:59], s[58:59], vcc
    s_mov_b64 exec, s[40:41]
    buffer_load_dwordx3 v[32:34], v56, s[16:19], 0 offen
    s_mov_b64 exec, s[42:43]
    buffer_load_dwordx3 v[36:38], v57, s[16:19], s37 offen
    s_mov_b64 exec, s[44:45]
    buffer_load_dwordx3 v[40:42], v58, s[16:19], s38 offen
    s_mov_b64 exec, s[46:47]
    buffer_load_dwordx3 v[44:46], v59, s[16:19], s39 offen
    s_mov_b64 exec, -1
    s_cmp_lg_u32 s81, 0
    s_cbranch_scc1 K2_wv0
    s_waitcnt vmcnt(5) lgkmcnt(0)
    s_branch K2_wvd
K2_wv0:
    s_cmp_lg_u32 s81, 1
    s_cbranch_scc1 K2_wv1
    s_waitcnt vmcnt(6) lgkmcnt(0)
    s_branch K2_wvd
K2_wv1:
    s_cmp_lg_u32 s81, 2
    s_cbranch_scc1 K2_wv2
    s_waitcnt vmcnt(7) lgkmcnt(0)
    s_branch K2_wvd
K2_wv2:
    s_cmp_lg_u32 s81, 3
    s_cbranch_scc1 K2_wv3
    s_waitcnt vmcnt(8) lgkmcnt(0)
    s_branch K2_wvd
K2_wv3:
    s_waitcnt vmcnt(9) lgkmcnt(0)
K2_wvd:
    s_barrier
    s_and_b32 s5, s5, 0xffff
    s_or_b32 s5, s5, 0x40000
    s_mov_b32 s6, 3200256
    s_mov_b32 s7, 0x800000
    s_cmp_lg_u64 s[56:57], 0
    s_cselect_b32 s64, 1, 0
    s_cmp_lg_u64 s[58:59], 0
    s_cselect_b32 s65, 2, 0
    s_or_b32 s64, s64, s65
    v_mov_b32 v89, s64
    v_mov_b32 v90, 1024
    s_mov_b64 exec, 1
    ds_or_b32 v90, v89
    s_mov_b64 exec, -1
    s_cmp_lt_u32 s28, 8
    s_cbranch_scc1 K2_noau
    s_cmp_eq_u32 s62, 0
    s_cbranch_scc1 K2_noau
    v_and_b32 v89, 31, v92
    v_lshrrev_b32 v90, 5, v92
    v_bfe_u32 v85, v92, 1, 3
    v_xor_b32 v85, v85, v90
    v_lshlrev_b32 v85, 4, v85
    v_lshl_add_u32 v85, v89, 7, v85
    s_and_b32 s64, s28, 1
    s_lshl_b32 s64, s64, 12
    s_add_u32 s64, s64, 120064
    v_xor_b32 v84, 0, v85
    v_add_u32 v84, s64, v84
    ds_read_b128 v[0:3], v84
    v_xor_b32 v84, 32, v85
    v_add_u32 v84, s64, v84
    ds_read_b128 v[4:7], v84
    v_xor_b32 v84, 64, v85
    v_add_u32 v84, s64, v84
    ds_read_b128 v[8:11], v84
    v_xor_b32 v84, 96, v85
    v_add_u32 v84, s64, v84
    ds_read_b128 v[12:15], v84
    s_bfe_u32 s67, s28, 0x20001
    s_lshl_b32 s67, s67, 12
    s_add_u32 s67, s67, 128256
    v_lshl_add_u32 v88, v92, 4, s67
    ds_read_b128 v[60:63], v88 offset:0
    ds_read_b128 v[64:67], v88 offset:1024
    ds_read_b128 v[68:71], v88 offset:2048
    ds_read_b128 v[72:75], v88 offset:3072
    s_waitcnt lgkmcnt(0)
    v_mfma_f32_32x32x16_bf16 v[16:31], v[0:3], v[60:63], 0
    v_mfma_f32_32x32x16_bf16 v[16:31], v[4:7], v[64:67], v[16:31]
    v_mfma_f32_32x32x16_bf16 v[16:31], v[8:11], v[68:71], v[16:31]
    v_mfma_f32_32x32x16_bf16 v[16:31], v[12:15], v[72:75], v[16:31]
    s_and_b32 s64, s28, 1
    s_lshl_b32 s64, s64, 13
    s_and_b32 s65, s28, 2
    s_lshl_b32 s65, s65, 6
    s_add_u32 s64, s64, s65
    s_and_b32 s65, s28, 4
    s_lshl_b32 s65, s65, 12
    s_add_u32 s64, s64, s65
    s_add_u32 s64, s64, 53504
    v_lshrrev_b32 v89, 5, v92
    v_and_b32 v90, 31, v92
    v_lshlrev_b32 v89, 10, v89
    v_lshl_add_u32 v89, v90, 2, v89
    v_add_u32 v89, s64, v89
    s_cmp_eq_u32 s65, 0
    s_cselect_b32 s64, 0xbfb8aa3b, 1.0
    s_cselect_b32 s65, 0xc2480000, 0
    v_mov_b32 v90, s65
    s_nop 3
    v_fma_f32 v16, v16, s64, v90
    ds_write_b32 v89, v16 offset:0
    v_fma_f32 v17, v17, s64, v90
    ds_write_b32 v89, v17 offset:256
    v_fma_f32 v18, v18, s64, v90
    ds_write_b32 v89, v18 offset:512
    v_fma_f32 v19, v19, s64, v90
    ds_write_b32 v89, v19 offset:768
    v_fma_f32 v20, v20, s64, v90
    ds_write_b32 v89, v20 offset:2048
    v_fma_f32 v21, v21, s64, v90
    ds_write_b32 v89, v21 offset:2304
    v_fma_f32 v22, v22, s64, v90
    ds_write_b32 v89, v22 offset:2560
    v_fma_f32 v23, v23, s64, v90
    ds_write_b32 v89, v23 offset:2816
    v_fma_f32 v24, v24, s64, v90
    ds_write_b32 v89, v24 offset:4096
    v_fma_f32 v25, v25, s64, v90
    ds_write_b32 v89, v25 offset:4352
    v_fma_f32 v26, v26, s64, v90
    ds_write_b32 v89, v26 offset:4608
    v_fma_f32 v27, v27, s64, v90
    ds_write_b32 v89, v27 offset:4864
    v_fma_f32 v28, v28, s64, v90
    ds_write_b32 v89, v28 offset:6144
    v_fma_f32 v29, v29, s64, v90
    ds_write_b32 v89, v29 offset:6400
    v_fma_f32 v30, v30, s64, v90
    ds_write_b32 v89, v30 offset:6656
    v_fma_f32 v31, v31, s64, v90
    ds_write_b32 v89, v31 offset:6912
K2_noau:
    v_mov_b32 v90, 1
    s_waitcnt vmcnt(3)
    v_and_b32 v48, 0xff, v34
    s_mov_b64 exec, s[40:41]
    ds_add_rtn_u32 v35, v48, v90 offset:0
    s_mov_b64 exec, -1
    v_and_b32 v34, 0xffffff00, v34
    s_waitcnt vmcnt(2)
    v_and_b32 v49, 0xff, v38
    s_mov_b64 exec, s[42:43]
    ds_add_rtn_u32 v39, v49, v90 offset:0
    s_mov_b64 exec, -1
    v_and_b32 v38, 0xffffff00, v38
    s_waitcnt vmcnt(1)
    v_and_b32 v50, 0xff, v42
    s_mov_b64 exec, s[44:45]
    ds_add_rtn_u32 v43, v50, v90 offset:0
    s_mov_b64 exec, -1
    v_and_b32 v42, 0xffffff00, v42
    s_waitcnt vmcnt(0)
    v_and_b32 v51, 0xff, v46
    s_mov_b64 exec, s[46:47]
    ds_add_rtn_u32 v47, v51, v90 offset:0
    s_mov_b64 exec, -1
    v_and_b32 v46, 0xffffff00, v46
    s_cmp_eq_u64 s[48:49], 0
    s_cbranch_scc1 K2_nh4
    v_and_b32 v52, 0xff, v98
    s_mov_b64 exec, s[48:49]
    ds_add_rtn_u32 v99, v52, v90 offset:256
    s_mov_b64 exec, -1
    v_and_b32 v98, 0xffffff00, v98
K2_nh4:
    s_cmp_eq_u64 s[50:51], 0
    s_cbranch_scc1 K2_nh5
    v_and_b32 v53, 0xff, v102
    s_mov_b64 exec, s[50:51]
    ds_add_rtn_u32 v103, v53, v90 offset:256
    s_mov_b64 exec, -1
    v_and_b32 v102, 0xffffff00, v102
K2_nh5:
    s_cmp_eq_u64 s[52:53], 0
    s_cbranch_scc1 K2_nh6
    v_and_b32 v54, 0xff, v106
    s_mov_b64 exec, s[52:53]
    ds_add_rtn_u32 v107, v54, v90 offset:256
    s_mov_b64 exec, -1
    v_and_b32 v106, 0xffffff00, v106
K2_nh6:
    s_cmp_eq_u64 s[54:55], 0
    s_cbranch_scc1 K2_nh7
    v_and_b32 v55, 0xff, v110
    s_mov_b64 exec, s[54:55]
    ds_add_rtn_u32 v111, v55, v90 offset:256
    s_mov_b64 exec, -1
    v_and_b32 v110, 0xffffff00, v110
K2_nh7:
    v_and_b32 v84, 3, v92
    v_cmp_eq_u32 vcc, 0, v84
    v_mov_b32 v116, 0x3f80
    s_nop 0
    v_cndmask_b32 v116, 0, v116, vcc
    v_cmp_eq_u32 vcc, 1, v84
    v_mov_b32 v117, 0x3f80
    s_nop 0
    v_cndmask_b32 v117, 0, v117, vcc
    v_cmp_eq_u32 vcc, 2, v84
    v_mov_b32 v74, 0x3f80
    s_nop 0
    v_cndmask_b32 v74, 0, v74, vcc
    v_cmp_eq_u32 vcc, 3, v84
    v_mov_b32 v75, 0x3f80
    s_nop 0
    v_cndmask_b32 v75, 0, v75, vcc
    v_lshlrev_b32 v89, 2, v92
    v_mov_b32 v88, 0
    s_waitcnt lgkmcnt(0)
    s_barrier
    ds_read2st64_b32 v[0:1], v89 offset0:0 offset1:1
    ds_read_b32 v2, v88 offset:1024
    s_mov_b32 s84, s4
    s_and_b32 s85, s5, 0xffff
    s_mov_b32 s86, 3200256
    s_mov_b32 s87, 0x20000
    s_and_b32 s64, s2, 31
    s_mul_i32 s64, s64, 784
    s_add_u32 s64, s64, s28
    v_lshl_add_u32 v85, v92, 4, s64
    v_lshlrev_b32 v85, 7, v85
    s_mov_b32 exec_lo, 0xffff
    s_mov_b32 exec_hi, 0x0
    buffer_load_dword v118, v85, s[84:87], 0 offen
    s_mov_b64 exec, -1
    s_mov_b32 s31, 32
    v_mov_b32 v7, 0x30d400
    v_mov_b32 v112, 0
    v_mov_b32 v113, 0
    s_waitcnt lgkmcnt(0)
    v_readfirstlane_b32 s61, v2
K2_scan:
    v_add_u32 v3, v0, v1
    v_add_u32 v4, 3, v3
    v_and_b32 v4, -4, v4
    v_mov_b32 v87, v4
    s_nop 1
    v_add_u32_dpp v87, v87, v87 row_shr:1 row_mask:0xf bank_mask:0xf bound_ctrl:0
    s_nop 1
    v_add_u32_dpp v87, v87, v87 row_shr:2 row_mask:0xf bank_mask:0xf bound_ctrl:0
    s_nop 1
    v_add_u32_dpp v87, v87, v87 row_shr:4 row_mask:0xf bank_mask:0xf bound_ctrl:0
    s_nop 1
    v_add_u32_dpp v87, v87, v87 row_shr:8 row_mask:0xf bank_mask:0xf bound_ctrl:0
    s_nop 1
    v_add_u32_dpp v87, v87, v87 row_bcast:15 row_mask:0xa bank_mask:0xf
    s_nop 1
    v_add_u32_dpp v87, v87, v87 row_bcast:31 row_mask:0xc bank_mask:0xf
    s_nop 0
    v_readlane_b32 s60, v87, 63
    v_sub_u32 v5, v87, v4
    v_add_u32 v6, v5, v0
    s_cmp_gt_u32 s60, 4224
    s_cbranch_scc1 K2_shrink
    s_cmp_eq_u64 s[48:49], 0
    s_cbranch_scc1 K2_nb4
    ds_bpermute_b32 v52, v52, v6
K2_nb4:
    s_cmp_eq_u64 s[50:51], 0
    s_cbranch_scc1 K2_nb5
    ds_bpermute_b32 v53, v53, v6
K2_nb5:
    s_cmp_eq_u64 s[52:53], 0
    s_cbranch_scc1 K2_nb6
    ds_bpermute_b32 v54, v54, v6
K2_nb6:
    s_cmp_eq_u64 s[54:55], 0
    s_cbranch_scc1 K2_nb7
    ds_bpermute_b32 v55, v55, v6
K2_nb7:
    ds_bpermute_b32 v48, v48, v5
    ds_bpermute_b32 v49, v49, v5
    ds_bpermute_b32 v50, v50, v5
    ds_bpermute_b32 v51, v51, v5
    s_lshr_b32 s64, s31, 4
    s_and_b32 s61, s61, s64
    s_add_u32 s64, s60, 15
    s_lshr_b32 s64, s64, 4
    s_add_u32 s30, s64, 15
    s_sub_u32 s30, s30, s28
    s_lshr_b32 s30, s30, 4
    s_lshr_b32 s65, s64, 4
    s_mul_i32 s65, s65, s28
    s_and_b32 s64, s64, 15
    s_min_u32 s64, s64, s28
    s_add_u32 s65, s65, s64
    s_lshl_b32 s65, s65, 4
    s_lshl_b32 s72, s30, 4
    s_add_u32 s72, s72, s65
    s_mov_b64 s[82:83], 0
    s_cmp_gt_u32 s28, 4
    s_cbranch_scc1 K2_nopad
    v_add_u32 v3, s28, v3
    v_cmp_lt_u32 s[82:83], v3, v4
    v_add_lshl_u32 v114, v5, v3, 2
    s_cmp_lt_u32 s28, 3
    s_cbranch_scc1 K2_pad
    s_lshl_b32 s64, s28, 6
    s_add_u32 s64, s64, s60
    s_sub_u32 s64, s64, 192
    v_add_lshl_u32 v114, v92, s64, 2
    s_mov_b64 s[82:83], -1
K2_pad:
    v_lshlrev_b32 v115, 1, v114
    s_mov_b64 exec, s[82:83]
    ds_write_b32 v114, v7 offset:1280
    s_mov_b64 exec, -1
    s_waitcnt lgkmcnt(1)
    s_branch K2_sc4
K2_nopad:
    s_waitcnt lgkmcnt(0)
K2_sc4:
    v_add_lshl_u32 v48, v48, v35, 2
    s_mov_b64 exec, s[40:41]
    ds_write_b32 v48, v34 offset:1280
    s_mov_b64 exec, -1
    v_lshlrev_b32 v35, 1, v48
    v_add_lshl_u32 v49, v49, v39, 2
    s_mov_b64 exec, s[42:43]
    ds_write_b32 v49, v38 offset:1280
    s_mov_b64 exec, -1
    v_lshlrev_b32 v39, 1, v49
    v_add_lshl_u32 v50, v50, v43, 2
    s_mov_b64 exec, s[44:45]
    ds_write_b32 v50, v42 offset:1280
    s_mov_b64 exec, -1
    v_lshlrev_b32 v43, 1, v50
    v_add_lshl_u32 v51, v51, v47, 2
    s_mov_b64 exec, s[46:47]
    ds_write_b32 v51, v46 offset:1280
    s_mov_b64 exec, -1
    v_lshlrev_b32 v47, 1, v51
    s_cmp_eq_u64 s[48:49], 0
    s_cbranch_scc1 K2_ns4
    v_add_lshl_u32 v52, v52, v99, 2
    s_mov_b64 exec, s[48:49]
    ds_write_b32 v52, v98 offset:1280
    s_mov_b64 exec, -1
    v_lshlrev_b32 v99, 1, v52
K2_ns4:
    s_cmp_eq_u64 s[50:51], 0
    s_cbranch_scc1 K2_ns5
    v_add_lshl_u32 v53, v53, v103, 2
    s_mov_b64 exec, s[50:51]
    ds_write_b32 v53, v102 offset:1280
    s_mov_b64 exec, -1
    v_lshlrev_b32 v103, 1, v53
K2_ns5:
    s_cmp_eq_u64 s[52:53], 0
    s_cbranch_scc1 K2_ns6
    v_add_lshl_u32 v54, v54, v107, 2
    s_mov_b64 exec, s[52:53]
    ds_write_b32 v54, v106 offset:1280
    s_mov_b64 exec, -1
    v_lshlrev_b32 v107, 1, v54
K2_ns6:
    s_cmp_eq_u64 s[54:55], 0
    s_cbranch_scc1 K2_ns7
    v_add_lshl_u32 v55, v55, v111, 2
    s_mov_b64 exec, s[54:55]
    ds_write_b32 v55, v110 offset:1280
    s_mov_b64 exec, -1
    v_lshlrev_b32 v111, 1, v55
K2_ns7:
    v_cmp_lt_u32 s[68:69], 0, v4
    v_cmp_lt_u32 vcc, s65, v87
    s_mov_b32 s64, 0x7fffffff
    v_writelane_b32 v87, s64, 49
    s_and_b64 s[68:69], s[68:69], vcc
    s_bitset1_b64 s[68:69], 49
    s_ff1_i32_b64 s66, s[68:69]
    s_bitset0_b64 s[68:69], s66
    v_readlane_b32 s73, v87, s66
    s_ff1_i32_b64 s79, s[68:69]
    s_mov_b64 s[70:71], s[68:69]
    s_bitset0_b64 s[70:71], s79
    s_lshl_b32 s64, s66, 8
    v_add_u32 v119, s64, v86
    s_lshl_b32 s64, s79, 8
    v_add_u32 v78, s64, v86
    s_cmp_ge_u32 s73, s72
    s_cselect_b32 s76, 1, 0
    s_min_u32 s73, s73, s72
    s_mov_b32 s80, s76
    s_mov_b32 s77, s73
    s_sub_u32 s78, s73, s65
    s_sub_u32 s74, s78, 1
    s_add_u32 s75, s28, 50
    s_lshl_b32 s75, s75, 8
    s_lshl_b32 s64, s65, 2
    v_mov_b32 v84, s64
    v_and_b32 v85, 15, v92
    v_add_lshl_u32 v85, v85, s65, 3
    v_mov_b64 v[80:81], 0
    v_mov_b64 v[82:83], 0
    s_lshl_b32 s64, s66, 2
    v_mov_b32 v88, s64
    v_mov_b32 v89, s28
    v_mov_b32 v90, 1
    s_cmp_eq_u32 s30, 0
    s_cselect_b64 exec, 0, 1
    ds_min_u32 v88, v89 offset:512
    ds_add_u32 v88, v90 offset:768
    s_mov_b64 exec, -1
    s_waitcnt lgkmcnt(0)
    s_barrier
    ds_read_b128 v[56:59], v84 offset:1280
    ds_read_b128 v[60:63], v84 offset:1296
    ds_read_b128 v[64:67], v84 offset:1312
    ds_read_b128 v[68:71], v84 offset:1328
    s_cmp_ge_u32 s28, 8
    s_cbranch_scc1 K2_late
    s_waitcnt lgkmcnt(0)
    buffer_load_dword v0, v56, s[4:7], 0 offen
    buffer_load_dword v1, v57, s[4:7], 0 offen
    buffer_load_dword v2, v58, s[4:7], 0 offen
    buffer_load_dword v3, v59, s[4:7], 0 offen
    buffer_load_dword v4, v60, s[4:7], 0 offen
    buffer_load_dword v5, v61, s[4:7], 0 offen
    buffer_load_dword v6, v62, s[4:7], 0 offen
    buffer_load_dword v7, v63, s[4:7], 0 offen
    buffer_load_dword v8, v64, s[4:7], 0 offen
    buffer_load_dword v9, v65, s[4:7], 0 offen
    buffer_load_dword v10, v66, s[4:7], 0 offen
    buffer_load_dword v11, v67, s[4:7], 0 offen
    buffer_load_dword v12, v68, s[4:7], 0 offen
    buffer_load_dword v13, v69, s[4:7], 0 offen
    buffer_load_dword v14, v70, s[4:7], 0 offen
    buffer_load_dword v15, v71, s[4:7], 0 offen
    ds_read_b128 v[56:59], v84 offset:1344
    ds_read_b128 v[60:63], v84 offset:1360
    ds_read_b128 v[64:67], v84 offset:1376
    ds_read_b128 v[68:71], v84 offset:1392
K2_late:
    s_mov_b64 exec, s[82:83]
    ds_write_b64 v115, v[112:113] offset:18688
    s_mov_b64 exec, s[40:41]
    ds_write_b64 v35, v[32:33] offset:18688
    s_mov_b64 exec, s[42:43]
    ds_write_b64 v39, v[36:37] offset:18688
    s_mov_b64 exec, s[44:45]
    ds_write_b64 v43, v[40:41] offset:18688
    s_mov_b64 exec, s[46:47]
    ds_write_b64 v47, v[44:45] offset:18688
    s_mov_b64 exec, s[48:49]
    s_cbranch_execz K2_ne4
    ds_write_b64 v99, v[96:97] offset:18688
K2_ne4:
    s_mov_b64 exec, s[50:51]
    s_cbranch_execz K2_ne5
    ds_write_b64 v103, v[100:101] offset:18688
K2_ne5:
    s_mov_b64 exec, s[52:53]
    s_cbranch_execz K2_ne6
    ds_write_b64 v107, v[104:105] offset:18688
K2_ne6:
    s_mov_b64 exec, s[54:55]
    s_cbranch_execz K2_ne7
    ds_write_b64 v111, v[108:109] offset:18688
K2_ne7:
    s_mov_b64 exec, -1
    s_waitcnt lgkmcnt(0)
    s_barrier
    s_cmp_eq_u32 s30, 0
    s_cbranch_scc1 K2_nowork
    ds_read_b64 v[72:73], v85 offset:18688
    ds_read2_b32 v[78:79], v78 offset0:0 offset1:0
    ds_read_b32 v112, v119 offset:0
    s_cmp_lt_u32 s28, 8
    s_cbranch_scc1 K2_early
    buffer_load_dword v0, v56, s[4:7], 0 offen
    buffer_load_dword v1, v57, s[4:7], 0 offen
    buffer_load_dword v2, v58, s[4:7], 0 offen
    buffer_load_dword v3, v59, s[4:7], 0 offen
    buffer_load_dword v4, v60, s[4:7], 0 offen
    buffer_load_dword v5, v61, s[4:7], 0 offen
    buffer_load_dword v6, v62, s[4:7], 0 offen
    buffer_load_dword v7, v63, s[4:7], 0 offen
    buffer_load_dword v8, v64, s[4:7], 0 offen
    buffer_load_dword v9, v65, s[4:7], 0 offen
    buffer_load_dword v10, v66, s[4:7], 0 offen
    buffer_load_dword v11, v67, s[4:7], 0 offen
    buffer_load_dword v12, v68, s[4:7], 0 offen
    buffer_load_dword v13, v69, s[4:7], 0 offen
    buffer_load_dword v14, v70, s[4:7], 0 offen
    buffer_load_dword v15, v71, s[4:7], 0 offen
    ds_read_b128 v[56:59], v84 offset:1344
    ds_read_b128 v[60:63], v84 offset:1360
    ds_read_b128 v[64:67], v84 offset:1376
    ds_read_b128 v[68:71], v84 offset:1392
K2_early:
    s_waitcnt lgkmcnt(0)
    buffer_load_dword v16, v56, s[4:7], 0 offen
    buffer_load_dword v17, v57, s[4:7], 0 offen
    buffer_load_dword v18, v58, s[4:7], 0 offen
    buffer_load_dword v19, v59, s[4:7], 0 offen
    buffer_load_dword v20, v60, s[4:7], 0 offen
    buffer_load_dword v21, v61, s[4:7], 0 offen
    buffer_load_dword v22, v62, s[4:7], 0 offen
    buffer_load_dword v23, v63, s[4:7], 0 offen
    buffer_load_dword v24, v64, s[4:7], 0 offen
    buffer_load_dword v25, v65, s[4:7], 0 offen
    buffer_load_dword v26, v66, s[4:7], 0 offen
    buffer_load_dword v27, v67, s[4:7], 0 offen
    buffer_load_dword v28, v68, s[4:7], 0 offen
    buffer_load_dword v29, v69, s[4:7], 0 offen
    buffer_load_dword v30, v70, s[4:7], 0 offen
    buffer_load_dword v31, v71, s[4:7], 0 offen
    ds_read_b128 v[56:59], v84 offset:1408
    ds_read_b128 v[60:63], v84 offset:1424
    ds_read_b128 v[64:67], v84 offset:1440
    ds_read_b128 v[68:71], v84 offset:1456
    v_lshrrev_b32 v108, 4, v91
    v_lshlrev_b32 v109, 2, v108
    ds_read2st64_b32 v[110:111], v109 offset0:2 offset1:3
    v_and_b32 v105, 15, v91
    v_lshlrev_b32 v105, 4, v105
    v_add_u32 v105, 53504, v105
    v_lshl_add_u32 v104, v108, 8, v105
    ds_read_b128 v[96:99], v104 offset:16384
    v_bfe_u32 v107, v91, 5, 3
    v_bfe_u32 v109, v91, 1, 3
    v_xor_b32 v107, v107, v109
    v_lshlrev_b32 v107, 1, v107
    v_and_b32 v109, 1, v91
    v_add_lshl_u32 v107, v107, v109, 3
    v_lshl_add_u32 v107, v108, 7, v107
    v_add_u32 v107, 120064, v107
    ds_read_b64 v[102:103], v107
    s_mul_i32 s64, s2, 6272
    v_lshl_add_u32 v107, v91, 3, s64
    v_cmp_gt_u32 vcc, 49, v108
    s_waitcnt lgkmcnt(0)
    v_cndmask_b32 v106, 0, v111, vcc
    v_add_u32 v110, 50, v110
    v_cmp_lt_u32 vcc, 0, v106
    v_mov_b32 v109, 49
    v_lshlrev_b32 v100, 16, v102
    v_cndmask_b32 v109, v109, v110, vcc
    v_and_b32 v101, 0xffff0000, v102
    v_lshlrev_b32 v102, 16, v103
    v_and_b32 v103, 0xffff0000, v103
    v_lshl_add_u32 v105, v109, 8, v105
    v_mov_b32 v113, v112
    v_mov_b32 v114, v112
    v_mov_b32 v115, v112
    s_setprio 3
    s_mov_b32 s36, 7
    s_sub_u32 s78, s78, 16
    s_max_u32 s81, s30, 2
    s_sub_u32 s81, s81, 2
    s_waitcnt vmcnt(16) lgkmcnt(4)
    s_add_u32 s78, s78, 16
    s_cmp_lg_u32 s78, 0
    s_cbranch_scc1 K2_sdp_0
    s_waitcnt lgkmcnt(0)
    v_readlane_b32 s64, v87, s79
    v_mov_b64 v[112:113], v[78:79]
    v_mov_b64 v[114:115], v[78:79]
    s_ff1_i32_b64 s79, s[70:71]
    s_bitset0_b64 s[70:71], s79
    s_lshl_b32 s67, s79, 8
    v_add_u32 v78, s67, v86
    s_cmp_ge_u32 s64, s72
    s_cselect_b32 s80, 1, 0
    s_min_u32 s64, s64, s72
    ds_read2_b32 v[78:79], v78 offset0:0 offset1:0
    s_sub_u32 s78, s64, s77
    s_mov_b32 s77, s64
K2_sdp_0:
    v_mfma_f32_4x4x4_16b_bf16 v[32:35], v[116:117], v[0:1], v[112:115]
    s_sub_u32 s78, s78, 4
    s_cmp_lg_u32 s78, 0
    s_cbranch_scc1 K2_sdp_1
    s_waitcnt lgkmcnt(0)
    v_readlane_b32 s64, v87, s79
    v_mov_b64 v[112:113], v[78:79]
    v_mov_b64 v[114:115], v[78:79]
    s_ff1_i32_b64 s79, s[70:71]
    s_bitset0_b64 s[70:71], s79
    s_lshl_b32 s67, s79, 8
    v_add_u32 v78, s67, v86
    s_cmp_ge_u32 s64, s72
    s_cselect_b32 s80, 1, 0
    s_min_u32 s64, s64, s72
    ds_read2_b32 v[78:79], v78 offset0:0 offset1:0
    s_sub_u32 s78, s64, s77
    s_mov_b32 s77, s64
K2_sdp_1:
    v_mfma_f32_4x4x4_16b_bf16 v[36:39], v[116:117], v[4:5], v[112:115]
    s_sub_u32 s78, s78, 4
    s_cmp_lg_u32 s78, 0
    s_cbranch_scc1 K2_sdp_2
    s_waitcnt lgkmcnt(0)
    v_readlane_b32 s64, v87, s79
    v_mov_b64 v[112:113], v[78:79]
    v_mov_b64 v[114:115], v[78:79]
    s_ff1_i32_b64 s79, s[70:71]
    s_bitset0_b64 s[70:71], s79
    s_lshl_b32 s67, s79, 8
    v_add_u32 v78, s67, v86
    s_cmp_ge_u32 s64, s72
    s_cselect_b32 s80, 1, 0
    s_min_u32 s64, s64, s72
    ds_read2_b32 v[78:79], v78 offset0:0 offset1:0
    s_sub_u32 s78, s64, s77
    s_mov_b32 s77, s64
K2_sdp_2:
    v_mfma_f32_4x4x4_16b_bf16 v[40:43], v[116:117], v[8:9], v[112:115]
    s_sub_u32 s78, s78, 4
    s_cmp_lg_u32 s78, 0
    s_cbranch_scc1 K2_sdp_3
    s_waitcnt lgkmcnt(0)
    v_readlane_b32 s64, v87, s79
    v_mov_b64 v[112:113], v[78:79]
    v_mov_b64 v[114:115], v[78:79]
    s_ff1_i32_b64 s79, s[70:71]
    s_bitset0_b64 s[70:71], s79
    s_lshl_b32 s67, s79, 8
    v_add_u32 v78, s67, v86
    s_cmp_ge_u32 s64, s72
    s_cselect_b32 s80, 1, 0
    s_min_u32 s64, s64, s72
    ds_read2_b32 v[78:79], v78 offset0:0 offset1:0
    s_sub_u32 s78, s64, s77
    s_mov_b32 s77, s64
K2_sdp_3:
    v_mfma_f32_4x4x4_16b_bf16 v[44:47], v[116:117], v[12:13], v[112:115]
    s_sub_u32 s78, s78, 4
    v_mfma_f32_4x4x4_16b_bf16 v[32:35], v[74:75], v[2:3], v[32:35]
    s_nop 0
    v_mfma_f32_4x4x4_16b_bf16 v[36:39], v[74:75], v[6:7], v[36:39]
    s_nop 0
    v_mfma_f32_4x4x4_16b_bf16 v[40:43], v[74:75], v[10:11], v[40:43]
    s_nop 0
    v_mfma_f32_4x4x4_16b_bf16 v[44:47], v[74:75], v[14:15], v[44:47]
    s_nop 0
    v_mfma_f32_4x4x4_16b_bf16 v[32:35], v[72:73], v[76:77], v[32:35] cbsz:4 abid:0
    s_nop 0
    v_mfma_f32_4x4x4_16b_bf16 v[36:39], v[72:73], v[76:77], v[36:39] cbsz:4 abid:1
    s_nop 0
    v_mfma_f32_4x4x4_16b_bf16 v[40:43], v[72:73], v[76:77], v[40:43] cbsz:4 abid:2
    s_nop 0
    v_mfma_f32_4x4x4_16b_bf16 v[44:47], v[72:73], v[76:77], v[44:47] cbsz:4 abid:3
    s_nop 0
    v_exp_f32 v32, v32 clamp
    v_exp_f32 v33, v33 clamp
    v_exp_f32 v34, v34 clamp
    v_exp_f32 v35, v35 clamp
    ds_read_b64 v[72:73], v85 offset:18816
    v_exp_f32 v36, v36 clamp
    v_exp_f32 v37, v37 clamp
    v_exp_f32 v38, v38 clamp
    v_exp_f32 v39, v39 clamp
.p2align 3
K2_top0:
    v_exp_f32 v40, v40 clamp
    v_exp_f32 v41, v41 clamp
    v_exp_f32 v42, v42 clamp
    v_exp_f32 v43, v43 clamp
    v_exp_f32 v44, v44 clamp
    v_exp_f32 v45, v45 clamp
    v_exp_f32 v46, v46 clamp
    v_exp_f32 v47, v47 clamp
    v_pk_fma_f32 v[32:33], v[32:33], s[32:33], 1.0 op_sel_hi:[1,1,0]
    v_pk_fma_f32 v[34:35], v[34:35], s[32:33], 1.0 op_sel_hi:[1,1,0]
    v_pk_fma_f32 v[36:37], v[36:37], s[32:33], 1.0 op_sel_hi:[1,1,0]
    v_pk_fma_f32 v[38:39], v[38:39], s[32:33], 1.0 op_sel_hi:[1,1,0]
    v_pk_fma_f32 v[40:41], v[40:41], s[32:33], 1.0 op_sel_hi:[1,1,0]
    v_pk_fma_f32 v[42:43], v[42:43], s[32:33], 1.0 op_sel_hi:[1,1,0]
    v_pk_fma_f32 v[44:45], v[44:45], s[32:33], 1.0 op_sel_hi:[1,1,0]
    v_pk_fma_f32 v[46:47], v[46:47], s[32:33], 1.0 op_sel_hi:[1,1,0]
    v_pk_mul_f32 v[0:1], v[34:35], v[0:1]
    v_pk_mul_f32 v[48:49], v[32:33], v[34:35]
    v_pk_fma_f32 v[0:1], v[32:33], v[2:3], v[0:1]
    v_pk_add_f32 v[2:3], v[32:33], v[34:35]
    v_pk_mul_f32 v[4:5], v[38:39], v[4:5]
    v_pk_mul_f32 v[50:51], v[36:37], v[38:39]
    v_pk_fma_f32 v[4:5], v[36:37], v[6:7], v[4:5]
    v_pk_add_f32 v[6:7], v[36:37], v[38:39]
    v_pk_mul_f32 v[8:9], v[42:43], v[8:9]
    v_pk_mul_f32 v[52:53], v[40:41], v[42:43]
    v_pk_fma_f32 v[8:9], v[40:41], v[10:11], v[8:9]
    v_pk_add_f32 v[10:11], v[40:41], v[42:43]
    v_pk_mul_f32 v[12:13], v[46:47], v[12:13]
    v_pk_mul_f32 v[54:55], v[44:45], v[46:47]
    v_pk_fma_f32 v[12:13], v[44:45], v[14:15], v[12:13]
    v_pk_add_f32 v[14:15], v[44:45], v[46:47]
    s_sub_u32 s78, s78, 16
    s_waitcnt vmcnt(0) lgkmcnt(4)
    s_cbranch_scc1 K2_sdot0
    v_mfma_f32_4x4x4_16b_bf16 v[32:35], v[116:117], v[16:17], v[112:115]
    v_rcp_f32 v48, v48
    v_mfma_f32_4x4x4_16b_bf16 v[36:39], v[116:117], v[20:21], v[112:115]
    v_rcp_f32 v49, v49
    v_mfma_f32_4x4x4_16b_bf16 v[32:35], v[74:75], v[18:19], v[32:35]
    v_rcp_f32 v50, v50
    v_mfma_f32_4x4x4_16b_bf16 v[36:39], v[74:75], v[22:23], v[36:39]
    v_rcp_f32 v51, v51
    v_mfma_f32_4x4x4_16b_bf16 v[32:35], v[72:73], v[76:77], v[32:35] cbsz:4 abid:0
    v_rcp_f32 v52, v52
    v_mfma_f32_4x4x4_16b_bf16 v[36:39], v[72:73], v[76:77], v[36:39] cbsz:4 abid:1
    v_rcp_f32 v53, v53
    v_mfma_f32_4x4x4_16b_bf16 v[40:43], v[116:117], v[24:25], v[112:115]
    v_rcp_f32 v54, v54
    v_mfma_f32_4x4x4_16b_bf16 v[44:47], v[116:117], v[28:29], v[112:115]
    v_rcp_f32 v55, v55
    v_mfma_f32_4x4x4_16b_bf16 v[40:43], v[74:75], v[26:27], v[40:43]
    v_exp_f32 v32, v32 clamp
    v_mfma_f32_4x4x4_16b_bf16 v[44:47], v[74:75], v[30:31], v[44:47]
    v_exp_f32 v33, v33 clamp
    v_mfma_f32_4x4x4_16b_bf16 v[40:43], v[72:73], v[76:77], v[40:43] cbsz:4 abid:2
    v_exp_f32 v34, v34 clamp
    v_mfma_f32_4x4x4_16b_bf16 v[44:47], v[72:73], v[76:77], v[44:47] cbsz:4 abid:3
    v_exp_f32 v35, v35 clamp
K2_mf0:
    ds_read_b64 v[72:73], v85 offset:18944
    v_exp_f32 v36, v36 clamp
    v_exp_f32 v37, v37 clamp
    v_exp_f32 v38, v38 clamp
    v_exp_f32 v39, v39 clamp
K2_acc0:
    s_sub_u32 s74, s74, 16
    s_cbranch_scc1 K2_sacc0
    v_pk_fma_f32 v[80:81], v[48:49], v[2:3], v[80:81]
    v_pk_fma_f32 v[82:83], v[48:49], v[0:1], v[82:83]
    v_pk_fma_f32 v[80:81], v[50:51], v[6:7], v[80:81]
    v_pk_fma_f32 v[82:83], v[50:51], v[4:5], v[82:83]
    v_pk_fma_f32 v[80:81], v[52:53], v[10:11], v[80:81]
    v_pk_fma_f32 v[82:83], v[52:53], v[8:9], v[82:83]
    v_pk_fma_f32 v[80:81], v[54:55], v[14:15], v[80:81]
    v_pk_fma_f32 v[82:83], v[54:55], v[12:13], v[82:83]
K2_ld0:
    s_cmp_eq_u32 s81, s36
    s_cbranch_scc1 K2_pr0
K2_prb0:
    s_sub_u32 s81, s81, 1
    s_cbranch_scc1 K2_nold0
    s_waitcnt lgkmcnt(1)
    buffer_load_dword v0, v56, s[4:7], 0 offen
    buffer_load_dword v1, v57, s[4:7], 0 offen
    buffer_load_dword v2, v58, s[4:7], 0 offen
    buffer_load_dword v3, v59, s[4:7], 0 offen
    buffer_load_dword v4, v60, s[4:7], 0 offen
    buffer_load_dword v5, v61, s[4:7], 0 offen
    buffer_load_dword v6, v62, s[4:7], 0 offen
    buffer_load_dword v7, v63, s[4:7], 0 offen
    buffer_load_dword v8, v64, s[4:7], 0 offen
    buffer_load_dword v9, v65, s[4:7], 0 offen
    buffer_load_dword v10, v66, s[4:7], 0 offen
    buffer_load_dword v11, v67, s[4:7], 0 offen
    buffer_load_dword v12, v68, s[4:7], 0 offen
    buffer_load_dword v13, v69, s[4:7], 0 offen
    buffer_load_dword v14, v70, s[4:7], 0 offen
    buffer_load_dword v15, v71, s[4:7], 0 offen
    ds_read_b128 v[56:59], v84 offset:1472
    ds_read_b128 v[60:63], v84 offset:1488
    ds_read_b128 v[64:67], v84 offset:1504
    ds_read_b128 v[68:71], v84 offset:1520
K2_nx0:
K2_top1:
    v_exp_f32 v40, v40 clamp
    v_exp_f32 v41, v41 clamp
    v_exp_f32 v42, v42 clamp
    v_exp_f32 v43, v43 clamp
    v_exp_f32 v44, v44 clamp
    v_exp_f32 v45, v45 clamp
    v_exp_f32 v46, v46 clamp
    v_exp_f32 v47, v47 clamp
    v_pk_fma_f32 v[32:33], v[32:33], s[32:33], 1.0 op_sel_hi:[1,1,0]
    v_pk_fma_f32 v[34:35], v[34:35], s[32:33], 1.0 op_sel_hi:[1,1,0]
    v_pk_fma_f32 v[36:37], v[36:37], s[32:33], 1.0 op_sel_hi:[1,1,0]
    v_pk_fma_f32 v[38:39], v[38:39], s[32:33], 1.0 op_sel_hi:[1,1,0]
    v_pk_fma_f32 v[40:41], v[40:41], s[32:33], 1.0 op_sel_hi:[1,1,0]
    v_pk_fma_f32 v[42:43], v[42:43], s[32:33], 1.0 op_sel_hi:[1,1,0]
    v_pk_fma_f32 v[44:45], v[44:45], s[32:33], 1.0 op_sel_hi:[1,1,0]
    v_pk_fma_f32 v[46:47], v[46:47], s[32:33], 1.0 op_sel_hi:[1,1,0]
    v_pk_mul_f32 v[16:17], v[34:35], v[16:17]
    v_pk_mul_f32 v[48:49], v[32:33], v[34:35]
    v_pk_fma_f32 v[16:17], v[32:33], v[18:19], v[16:17]
    v_pk_add_f32 v[18:19], v[32:33], v[34:35]
    v_pk_mul_f32 v[20:21], v[38:39], v[20:21]
    v_pk_mul_f32 v[50:51], v[36:37], v[38:39]
    v_pk_fma_f32 v[20:21], v[36:37], v[22:23], v[20:21]
    v_pk_add_f32 v[22:23], v[36:37], v[38:39]
    v_pk_mul_f32 v[24:25], v[42:43], v[24:25]
    v_pk_mul_f32 v[52:53], v[40:41], v[42:43]
    v_pk_fma_f32 v[24:25], v[40:41], v[26:27], v[24:25]
    v_pk_add_f32 v[26:27], v[40:41], v[42:43]
    v_pk_mul_f32 v[28:29], v[46:47], v[28:29]
    v_pk_mul_f32 v[54:55], v[44:45], v[46:47]
    v_pk_fma_f32 v[28:29], v[44:45], v[30:31], v[28:29]
    v_pk_add_f32 v[30:31], v[44:45], v[46:47]
    s_sub_u32 s78, s78, 16
    s_waitcnt vmcnt(0) lgkmcnt(4)
    s_cbranch_scc1 K2_sdot1
    v_mfma_f32_4x4x4_16b_bf16 v[32:35], v[116:117], v[0:1], v[112:115]
    v_rcp_f32 v48, v48
    v_mfma_f32_4x4x4_16b_bf16 v[36:39], v[116:117], v[4:5], v[112:115]
    v_rcp_f32 v49, v49
    v_mfma_f32_4x4x4_16b_bf16 v[32:35], v[74:75], v[2:3], v[32:35]
    v_rcp_f32 v50, v50
    v_mfma_f32_4x4x4_16b_bf16 v[36:39], v[74:75], v[6:7], v[36:39]
    v_rcp_f32 v51, v51
    v_mfma_f32_4x4x4_16b_bf16 v[32:35], v[72:73], v[76:77], v[32:35] cbsz:4 abid:0
    v_rcp_f32 v52, v52
    v_mfma_f32_4x4x4_16b_bf16 v[36:39], v[72:73], v[76:77], v[36:39] cbsz:4 abid:1
    v_rcp_f32 v53, v53
    v_mfma_f32_4x4x4_16b_bf16 v[40:43], v[116:117], v[8:9], v[112:115]
    v_rcp_f32 v54, v54
    v_mfma_f32_4x4x4_16b_bf16 v[44:47], v[116:117], v[12:13], v[112:115]
    v_rcp_f32 v55, v55
    v_mfma_f32_4x4x4_16b_bf16 v[40:43], v[74:75], v[10:11], v[40:43]
    v_exp_f32 v32, v32 clamp
    v_mfma_f32_4x4x4_16b_bf16 v[44:47], v[74:75], v[14:15], v[44:47]
    v_exp_f32 v33, v33 clamp
    v_mfma_f32_4x4x4_16b_bf16 v[40:43], v[72:73], v[76:77], v[40:43] cbsz:4 abid:2
    v_exp_f32 v34, v34 clamp
    v_mfma_f32_4x4x4_16b_bf16 v[44:47], v[72:73], v[76:77], v[44:47] cbsz:4 abid:3
    v_exp_f32 v35, v35 clamp
K2_mf1:
    ds_read_b64 v[72:73], v85 offset:19072
    v_exp_f32 v36, v36 clamp
    v_exp_f32 v37, v37 clamp
    v_exp_f32 v38, v38 clamp
    v_exp_f32 v39, v39 clamp
K2_acc1:
    s_sub_u32 s74, s74, 16
    s_cbranch_scc1 K2_sacc1
    v_pk_fma_f32 v[80:81], v[48:49], v[18:19], v[80:81]
    v_pk_fma_f32 v[82:83], v[48:49], v[16:17], v[82:83]
    v_pk_fma_f32 v[80:81], v[50:51], v[22:23], v[80:81]
    v_pk_fma_f32 v[82:83], v[50:51], v[20:21], v[82:83]
    v_pk_fma_f32 v[80:81], v[52:53], v[26:27], v[80:81]
    v_pk_fma_f32 v[82:83], v[52:53], v[24:25], v[82:83]
    v_pk_fma_f32 v[80:81], v[54:55], v[30:31], v[80:81]
    v_pk_fma_f32 v[82:83], v[54:55], v[28:29], v[82:83]
K2_ld1:
    s_cmp_eq_u32 s81, s36
    s_cbranch_scc1 K2_pr1
K2_prb1:
    s_sub_u32 s81, s81, 1
    s_cbranch_scc1 K2_nold1
    s_waitcnt lgkmcnt(1)
    buffer_load_dword v16, v56, s[4:7], 0 offen
    buffer_load_dword v17, v57, s[4:7], 0 offen
    buffer_load_dword v18, v58, s[4:7], 0 offen
    buffer_load_dword v19, v59, s[4:7], 0 offen
    buffer_load_dword v20, v60, s[4:7], 0 offen
    buffer_load_dword v21, v61, s[4:7], 0 offen
    buffer_load_dword v22, v62, s[4:7], 0 offen
    buffer_load_dword v23, v63, s[4:7], 0 offen
    buffer_load_dword v24, v64, s[4:7], 0 offen
    buffer_load_dword v25, v65, s[4:7], 0 offen
    buffer_load_dword v26, v66, s[4:7], 0 offen
    buffer_load_dword v27, v67, s[4:7], 0 offen
    buffer_load_dword v28, v68, s[4:7], 0 offen
    buffer_load_dword v29, v69, s[4:7], 0 offen
    buffer_load_dword v30, v70, s[4:7], 0 offen
    buffer_load_dword v31, v71, s[4:7], 0 offen
    ds_read_b128 v[56:59], v84 offset:1536
    ds_read_b128 v[60:63], v84 offset:1552
    ds_read_b128 v[64:67], v84 offset:1568
    ds_read_b128 v[68:71], v84 offset:1584
K2_nx1:
    v_add_u32 v84, 128, v84
    v_add_u32 v85, 256, v85
    s_branch K2_top0
K2_pr0:
    s_cmp_eq_u32 s36, 7
    s_cbranch_scc0 K2_prc0
    s_setprio 2
    s_mov_b32 s36, 4
    s_branch K2_prb0
K2_prc0:
    s_cmp_eq_u32 s36, 4
    s_cbranch_scc0 K2_prd0
    s_setprio 1
    s_mov_b32 s36, 1
    s_branch K2_prb0
K2_prd0:
    s_setprio 0
    s_mov_b32 s36, -1
    s_branch K2_prb0
K2_nold0:
    s_mov_b32 s81, 0
    s_waitcnt vmcnt(0) lgkmcnt(0)
    s_branch K2_nx0
K2_sdot0:
    s_cmp_eq_u32 s80, 0
    s_cbranch_scc1 K2_sdq0
    v_rcp_f32 v48, v48
    v_rcp_f32 v49, v49
    v_rcp_f32 v50, v50
    v_rcp_f32 v51, v51
    v_rcp_f32 v52, v52
    v_rcp_f32 v53, v53
    v_rcp_f32 v54, v54
    v_rcp_f32 v55, v55
    s_branch K2_acc0
K2_sdq0:
    s_add_u32 s78, s78, 16
    s_cmp_lg_u32 s78, 0
    s_cbranch_scc1 K2_sd0_0
    s_waitcnt lgkmcnt(0)
    v_readlane_b32 s64, v87, s79
    v_mov_b64 v[112:113], v[78:79]
    v_mov_b64 v[114:115], v[78:79]
    s_ff1_i32_b64 s79, s[70:71]
    s_bitset0_b64 s[70:71], s79
    s_lshl_b32 s67, s79, 8
    v_add_u32 v78, s67, v86
    s_cmp_ge_u32 s64, s72
    s_cselect_b32 s80, 1, 0
    s_min_u32 s64, s64, s72
    ds_read2_b32 v[78:79], v78 offset0:0 offset1:0
    s_sub_u32 s78, s64, s77
    s_mov_b32 s77, s64
K2_sd0_0:
    v_mfma_f32_4x4x4_16b_bf16 v[32:35], v[116:117], v[16:17], v[112:115]
    s_sub_u32 s78, s78, 4
    s_cmp_lg_u32 s78, 0
    s_cbranch_scc1 K2_sd0_1
    s_waitcnt lgkmcnt(0)
    v_readlane_b32 s64, v87, s79
    v_mov_b64 v[112:113], v[78:79]
    v_mov_b64 v[114:115], v[78:79]
    s_ff1_i32_b64 s79, s[70:71]
    s_bitset0_b64 s[70:71], s79
    s_lshl_b32 s67, s79, 8
    v_add_u32 v78, s67, v86
    s_cmp_ge_u32 s64, s72
    s_cselect_b32 s80, 1, 0
    s_min_u32 s64, s64, s72
    ds_read2_b32 v[78:79], v78 offset0:0 offset1:0
    s_sub_u32 s78, s64, s77
    s_mov_b32 s77, s64
K2_sd0_1:
    v_mfma_f32_4x4x4_16b_bf16 v[36:39], v[116:117], v[20:21], v[112:115]
    s_sub_u32 s78, s78, 4
    s_cmp_lg_u32 s78, 0
    s_cbranch_scc1 K2_sd0_2
    s_waitcnt lgkmcnt(0)
    v_readlane_b32 s64, v87, s79
    v_mov_b64 v[112:113], v[78:79]
    v_mov_b64 v[114:115], v[78:79]
    s_ff1_i32_b64 s79, s[70:71]
    s_bitset0_b64 s[70:71], s79
    s_lshl_b32 s67, s79, 8
    v_add_u32 v78, s67, v86
    s_cmp_ge_u32 s64, s72
    s_cselect_b32 s80, 1, 0
    s_min_u32 s64, s64, s72
    ds_read2_b32 v[78:79], v78 offset0:0 offset1:0
    s_sub_u32 s78, s64, s77
    s_mov_b32 s77, s64
K2_sd0_2:
    v_mfma_f32_4x4x4_16b_bf16 v[40:43], v[116:117], v[24:25], v[112:115]
    s_sub_u32 s78, s78, 4
    s_cmp_lg_u32 s78, 0
    s_cbranch_scc1 K2_sd0_3
    s_waitcnt lgkmcnt(0)
    v_readlane_b32 s64, v87, s79
    v_mov_b64 v[112:113], v[78:79]
    v_mov_b64 v[114:115], v[78:79]
    s_ff1_i32_b64 s79, s[70:71]
    s_bitset0_b64 s[70:71], s79
    s_lshl_b32 s67, s79, 8
    v_add_u32 v78, s67, v86
    s_cmp_ge_u32 s64, s72
    s_cselect_b32 s80, 1, 0
    s_min_u32 s64, s64, s72
    ds_read2_b32 v[78:79], v78 offset0:0 offset1:0
    s_sub_u32 s78, s64, s77
    s_mov_b32 s77, s64
K2_sd0_3:
    v_mfma_f32_4x4x4_16b_bf16 v[44:47], v[116:117], v[28:29], v[112:115]
    s_sub_u32 s78, s78, 4
    v_mfma_f32_4x4x4_16b_bf16 v[32:35], v[74:75], v[18:19], v[32:35]
    v_rcp_f32 v48, v48
    v_mfma_f32_4x4x4_16b_bf16 v[36:39], v[74:75], v[22:23], v[36:39]
    v_rcp_f32 v49, v49
    v_mfma_f32_4x4x4_16b_bf16 v[40:43], v[74:75], v[26:27], v[40:43]
    v_rcp_f32 v50, v50
    v_mfma_f32_4x4x4_16b_bf16 v[44:47], v[74:75], v[30:31], v[44:47]
    v_rcp_f32 v51, v51
    v_mfma_f32_4x4x4_16b_bf16 v[32:35], v[72:73], v[76:77], v[32:35] cbsz:4 abid:0
    v_rcp_f32 v52, v52
    v_mfma_f32_4x4x4_16b_bf16 v[36:39], v[72:73], v[76:77], v[36:39] cbsz:4 abid:1
    v_rcp_f32 v53, v53
    v_mfma_f32_4x4x4_16b_bf16 v[40:43], v[72:73], v[76:77], v[40:43] cbsz:4 abid:2
    v_rcp_f32 v54, v54
    v_mfma_f32_4x4x4_16b_bf16 v[44:47], v[72:73], v[76:77], v[44:47] cbsz:4 abid:3
    v_rcp_f32 v55, v55
    v_exp_f32 v32, v32 clamp
    v_exp_f32 v33, v33 clamp
    v_exp_f32 v34, v34 clamp
    v_exp_f32 v35, v35 clamp
    s_branch K2_mf0
K2_sacc0:
    s_add_u32 s74, s74, 16
    v_pk_fma_f32 v[80:81], v[48:49], v[2:3], v[80:81]
    v_pk_fma_f32 v[82:83], v[48:49], v[0:1], v[82:83]
    s_sub_u32 s74, s74, 4
    s_cbranch_scc0 K2_sa0_0
    v_add_f32 v89, v82, v83
    v_add_f32 v90, v80, v81
    v_add_u32 v88, s75, v86
    v_mov_b64 v[82:83], 0
    v_mov_b64 v[80:81], 0
    ds_write_b32 v88, v89 offset:32768
    ds_write_b32 v88, v90 offset:49664
    s_cmp_lg_u32 s76, 0
    s_cbranch_scc1 K2_done
    s_ff1_i32_b64 s66, s[68:69]
    s_bitset0_b64 s[68:69], s66
    v_readlane_b32 s64, v87, s66
    s_lshl_b32 s75, s66, 8
    s_cmp_ge_u32 s64, s72
    s_cselect_b32 s76, 1, 0
    s_min_u32 s64, s64, s72
    s_sub_u32 s74, s64, s73
    s_sub_u32 s74, s74, 1
    s_mov_b32 s73, s64
K2_sa0_0:
    v_pk_fma_f32 v[80:81], v[50:51], v[6:7], v[80:81]
    v_pk_fma_f32 v[82:83], v[50:51], v[4:5], v[82:83]
    s_sub_u32 s74, s74, 4
    s_cbranch_scc0 K2_sa0_1
    v_add_f32 v89, v82, v83
    v_add_f32 v90, v80, v81
    v_add_u32 v88, s75, v86
    v_mov_b64 v[82:83], 0
    v_mov_b64 v[80:81], 0
    ds_write_b32 v88, v89 offset:32768
    ds_write_b32 v88, v90 offset:49664
    s_cmp_lg_u32 s76, 0
    s_cbranch_scc1 K2_done
    s_ff1_i32_b64 s66, s[68:69]
    s_bitset0_b64 s[68:69], s66
    v_readlane_b32 s64, v87, s66
    s_lshl_b32 s75, s66, 8
    s_cmp_ge_u32 s64, s72
    s_cselect_b32 s76, 1, 0
    s_min_u32 s64, s64, s72
    s_sub_u32 s74, s64, s73
    s_sub_u32 s74, s74, 1
    s_mov_b32 s73, s64
K2_sa0_1:
    v_pk_fma_f32 v[80:81], v[52:53], v[10:11], v[80:81]
    v_pk_fma_f32 v[82:83], v[52:53], v[8:9], v[82:83]
    s_sub_u32 s74, s74, 4
    s_cbranch_scc0 K2_sa0_2
    v_add_f32 v89, v82, v83
    v_add_f32 v90, v80, v81
    v_add_u32 v88, s75, v86
    v_mov_b64 v[82:83], 0
    v_mov_b64 v[80:81], 0
    ds_write_b32 v88, v89 offset:32768
    ds_write_b32 v88, v90 offset:49664
    s_cmp_lg_u32 s76, 0
    s_cbranch_scc1 K2_done
    s_ff1_i32_b64 s66, s[68:69]
    s_bitset0_b64 s[68:69], s66
    v_readlane_b32 s64, v87, s66
    s_lshl_b32 s75, s66, 8
    s_cmp_ge_u32 s64, s72
    s_cselect_b32 s76, 1, 0
    s_min_u32 s64, s64, s72
    s_sub_u32 s74, s64, s73
    s_sub_u32 s74, s74, 1
    s_mov_b32 s73, s64
K2_sa0_2:
    v_pk_fma_f32 v[80:81], v[54:55], v[14:15], v[80:81]
    v_pk_fma_f32 v[82:83], v[54:55], v[12:13], v[82:83]
    s_sub_u32 s74, s74, 4
    s_cbranch_scc0 K2_sa0_3
    v_add_f32 v89, v82, v83
    v_add_f32 v90, v80, v81
    v_add_u32 v88, s75, v86
    v_mov_b64 v[82:83], 0
    v_mov_b64 v[80:81], 0
    ds_write_b32 v88, v89 offset:32768
    ds_write_b32 v88, v90 offset:49664
    s_cmp_lg_u32 s76, 0
    s_cbranch_scc1 K2_done
    s_ff1_i32_b64 s66, s[68:69]
    s_bitset0_b64 s[68:69], s66
    v_readlane_b32 s64, v87, s66
    s_lshl_b32 s75, s66, 8
    s_cmp_ge_u32 s64, s72
    s_cselect_b32 s76, 1, 0
    s_min_u32 s64, s64, s72
    s_sub_u32 s74, s64, s73
    s_sub_u32 s74, s74, 1
    s_mov_b32 s73, s64
K2_sa0_3:
    s_branch K2_ld0
K2_pr1:
    s_cmp_eq_u32 s36, 7
    s_cbranch_scc0 K2_prc1
    s_setprio 2
    s_mov_b32 s36, 4
    s_branch K2_prb1
K2_prc1:
    s_cmp_eq_u32 s36, 4
    s_cbranch_scc0 K2_prd1
    s_setprio 1
    s_mov_b32 s36, 1
    s_branch K2_prb1
K2_prd1:
    s_setprio 0
    s_mov_b32 s36, -1
    s_branch K2_prb1
K2_nold1:
    s_mov_b32 s81, 0
    s_waitcnt vmcnt(0) lgkmcnt(0)
    s_branch K2_nx1
K2_sdot1:
    s_cmp_eq_u32 s80, 0
    s_cbranch_scc1 K2_sdq1
    v_rcp_f32 v48, v48
    v_rcp_f32 v49, v49
    v_rcp_f32 v50, v50
    v_rcp_f32 v51, v51
    v_rcp_f32 v52, v52
    v_rcp_f32 v53, v53
    v_rcp_f32 v54, v54
    v_rcp_f32 v55, v55
    s_branch K2_acc1
K2_sdq1:
    s_add_u32 s78, s78, 16
    s_cmp_lg_u32 s78, 0
    s_cbranch_scc1 K2_sd1_0
    s_waitcnt lgkmcnt(0)
    v_readlane_b32 s64, v87, s79
    v_mov_b64 v[112:113], v[78:79]
    v_mov_b64 v[114:115], v[78:79]
    s_ff1_i32_b64 s79, s[70:71]
    s_bitset0_b64 s[70:71], s79
    s_lshl_b32 s67, s79, 8
    v_add_u32 v78, s67, v86
    s_cmp_ge_u32 s64, s72
    s_cselect_b32 s80, 1, 0
    s_min_u32 s64, s64, s72
    ds_read2_b32 v[78:79], v78 offset0:0 offset1:0
    s_sub_u32 s78, s64, s77
    s_mov_b32 s77, s64
K2_sd1_0:
    v_mfma_f32_4x4x4_16b_bf16 v[32:35], v[116:117], v[0:1], v[112:115]
    s_sub_u32 s78, s78, 4
    s_cmp_lg_u32 s78, 0
    s_cbranch_scc1 K2_sd1_1
    s_waitcnt lgkmcnt(0)
    v_readlane_b32 s64, v87, s79
    v_mov_b64 v[112:113], v[78:79]
    v_mov_b64 v[114:115], v[78:79]
    s_ff1_i32_b64 s79, s[70:71]
    s_bitset0_b64 s[70:71], s79
    s_lshl_b32 s67, s79, 8
    v_add_u32 v78, s67, v86
    s_cmp_ge_u32 s64, s72
    s_cselect_b32 s80, 1, 0
    s_min_u32 s64, s64, s72
    ds_read2_b32 v[78:79], v78 offset0:0 offset1:0
    s_sub_u32 s78, s64, s77
    s_mov_b32 s77, s64
K2_sd1_1:
    v_mfma_f32_4x4x4_16b_bf16 v[36:39], v[116:117], v[4:5], v[112:115]
    s_sub_u32 s78, s78, 4
    s_cmp_lg_u32 s78, 0
    s_cbranch_scc1 K2_sd1_2
    s_waitcnt lgkmcnt(0)
    v_readlane_b32 s64, v87, s79
    v_mov_b64 v[112:113], v[78:79]
    v_mov_b64 v[114:115], v[78:79]
    s_ff1_i32_b64 s79, s[70:71]
    s_bitset0_b64 s[70:71], s79
    s_lshl_b32 s67, s79, 8
    v_add_u32 v78, s67, v86
    s_cmp_ge_u32 s64, s72
    s_cselect_b32 s80, 1, 0
    s_min_u32 s64, s64, s72
    ds_read2_b32 v[78:79], v78 offset0:0 offset1:0
    s_sub_u32 s78, s64, s77
    s_mov_b32 s77, s64
K2_sd1_2:
    v_mfma_f32_4x4x4_16b_bf16 v[40:43], v[116:117], v[8:9], v[112:115]
    s_sub_u32 s78, s78, 4
    s_cmp_lg_u32 s78, 0
    s_cbranch_scc1 K2_sd1_3
    s_waitcnt lgkmcnt(0)
    v_readlane_b32 s64, v87, s79
    v_mov_b64 v[112:113], v[78:79]
    v_mov_b64 v[114:115], v[78:79]
    s_ff1_i32_b64 s79, s[70:71]
    s_bitset0_b64 s[70:71], s79
    s_lshl_b32 s67, s79, 8
    v_add_u32 v78, s67, v86
    s_cmp_ge_u32 s64, s72
    s_cselect_b32 s80, 1, 0
    s_min_u32 s64, s64, s72
    ds_read2_b32 v[78:79], v78 offset0:0 offset1:0
    s_sub_u32 s78, s64, s77
    s_mov_b32 s77, s64
K2_sd1_3:
    v_mfma_f32_4x4x4_16b_bf16 v[44:47], v[116:117], v[12:13], v[112:115]
    s_sub_u32 s78, s78, 4
    v_mfma_f32_4x4x4_16b_bf16 v[32:35], v[74:75], v[2:3], v[32:35]
    v_rcp_f32 v48, v48
    v_mfma_f32_4x4x4_16b_bf16 v[36:39], v[74:75], v[6:7], v[36:39]
    v_rcp_f32 v49, v49
    v_mfma_f32_4x4x4_16b_bf16 v[40:43], v[74:75], v[10:11], v[40:43]
    v_rcp_f32 v50, v50
    v_mfma_f32_4x4x4_16b_bf16 v[44:47], v[74:75], v[14:15], v[44:47]
    v_rcp_f32 v51, v51
    v_mfma_f32_4x4x4_16b_bf16 v[32:35], v[72:73], v[76:77], v[32:35] cbsz:4 abid:0
    v_rcp_f32 v52, v52
    v_mfma_f32_4x4x4_16b_bf16 v[36:39], v[72:73], v[76:77], v[36:39] cbsz:4 abid:1
    v_rcp_f32 v53, v53
    v_mfma_f32_4x4x4_16b_bf16 v[40:43], v[72:73], v[76:77], v[40:43] cbsz:4 abid:2
    v_rcp_f32 v54, v54
    v_mfma_f32_4x4x4_16b_bf16 v[44:47], v[72:73], v[76:77], v[44:47] cbsz:4 abid:3
    v_rcp_f32 v55, v55
    v_exp_f32 v32, v32 clamp
    v_exp_f32 v33, v33 clamp
    v_exp_f32 v34, v34 clamp
    v_exp_f32 v35, v35 clamp
    s_branch K2_mf1
K2_sacc1:
    s_add_u32 s74, s74, 16
    v_pk_fma_f32 v[80:81], v[48:49], v[18:19], v[80:81]
    v_pk_fma_f32 v[82:83], v[48:49], v[16:17], v[82:83]
    s_sub_u32 s74, s74, 4
    s_cbranch_scc0 K2_sa1_0
    v_add_f32 v89, v82, v83
    v_add_f32 v90, v80, v81
    v_add_u32 v88, s75, v86
    v_mov_b64 v[82:83], 0
    v_mov_b64 v[80:81], 0
    ds_write_b32 v88, v89 offset:32768
    ds_write_b32 v88, v90 offset:49664
    s_cmp_lg_u32 s76, 0
    s_cbranch_scc1 K2_done
    s_ff1_i32_b64 s66, s[68:69]
    s_bitset0_b64 s[68:69], s66
    v_readlane_b32 s64, v87, s66
    s_lshl_b32 s75, s66, 8
    s_cmp_ge_u32 s64, s72
    s_cselect_b32 s76, 1, 0
    s_min_u32 s64, s64, s72
    s_sub_u32 s74, s64, s73
    s_sub_u32 s74, s74, 1
    s_mov_b32 s73, s64
K2_sa1_0:
    v_pk_fma_f32 v[80:81], v[50:51], v[22:23], v[80:81]
    v_pk_fma_f32 v[82:83], v[50:51], v[20:21], v[82:83]
    s_sub_u32 s74, s74, 4
    s_cbranch_scc0 K2_sa1_1
    v_add_f32 v89, v82, v83
    v_add_f32 v90, v80, v81
    v_add_u32 v88, s75, v86
    v_mov_b64 v[82:83], 0
    v_mov_b64 v[80:81], 0
    ds_write_b32 v88, v89 offset:32768
    ds_write_b32 v88, v90 offset:49664
    s_cmp_lg_u32 s76, 0
    s_cbranch_scc1 K2_done
    s_ff1_i32_b64 s66, s[68:69]
    s_bitset0_b64 s[68:69], s66
    v_readlane_b32 s64, v87, s66
    s_lshl_b32 s75, s66, 8
    s_cmp_ge_u32 s64, s72
    s_cselect_b32 s76, 1, 0
    s_min_u32 s64, s64, s72
    s_sub_u32 s74, s64, s73
    s_sub_u32 s74, s74, 1
    s_mov_b32 s73, s64
K2_sa1_1:
    v_pk_fma_f32 v[80:81], v[52:53], v[26:27], v[80:81]
    v_pk_fma_f32 v[82:83], v[52:53], v[24:25], v[82:83]
    s_sub_u32 s74, s74, 4
    s_cbranch_scc0 K2_sa1_2
    v_add_f32 v89, v82, v83
    v_add_f32 v90, v80, v81
    v_add_u32 v88, s75, v86
    v_mov_b64 v[82:83], 0
    v_mov_b64 v[80:81], 0
    ds_write_b32 v88, v89 offset:32768
    ds_write_b32 v88, v90 offset:49664
    s_cmp_lg_u32 s76, 0
    s_cbranch_scc1 K2_done
    s_ff1_i32_b64 s66, s[68:69]
    s_bitset0_b64 s[68:69], s66
    v_readlane_b32 s64, v87, s66
    s_lshl_b32 s75, s66, 8
    s_cmp_ge_u32 s64, s72
    s_cselect_b32 s76, 1, 0
    s_min_u32 s64, s64, s72
    s_sub_u32 s74, s64, s73
    s_sub_u32 s74, s74, 1
    s_mov_b32 s73, s64
K2_sa1_2:
    v_pk_fma_f32 v[80:81], v[54:55], v[30:31], v[80:81]
    v_pk_fma_f32 v[82:83], v[54:55], v[28:29], v[82:83]
    s_sub_u32 s74, s74, 4
    s_cbranch_scc0 K2_sa1_3
    v_add_f32 v89, v82, v83
    v_add_f32 v90, v80, v81
    v_add_u32 v88, s75, v86
    v_mov_b64 v[82:83], 0
    v_mov_b64 v[80:81], 0
    ds_write_b32 v88, v89 offset:32768
    ds_write_b32 v88, v90 offset:49664
    s_cmp_lg_u32 s76, 0
    s_cbranch_scc1 K2_done
    s_ff1_i32_b64 s66, s[68:69]
    s_bitset0_b64 s[68:69], s66
    v_readlane_b32 s64, v87, s66
    s_lshl_b32 s75, s66, 8
    s_cmp_ge_u32 s64, s72
    s_cselect_b32 s76, 1, 0
    s_min_u32 s64, s64, s72
    s_sub_u32 s74, s64, s73
    s_sub_u32 s74, s74, 1
    s_mov_b32 s73, s64
K2_sa1_3:
    s_branch K2_ld1
K2_done:
    s_setprio 0
    s_waitcnt vmcnt(0) lgkmcnt(0)
    s_barrier
    ds_read_b128 v[0:3], v104 offset:32768
    ds_read_b128 v[4:7], v104 offset:49664
K2_heads:
    ds_read_b128 v[8:11], v105 offset:32768
    ds_read_b128 v[12:15], v105 offset:49664
    v_cmp_lt_u32 vcc, 1, v106
    s_waitcnt lgkmcnt(0)
    v_pk_add_f32 v[0:1], v[0:1], v[8:9]
    v_pk_add_f32 v[2:3], v[2:3], v[10:11]
    v_pk_add_f32 v[4:5], v[4:5], v[12:13]
    v_pk_add_f32 v[6:7], v[6:7], v[14:15]
    s_cbranch_vccnz K2_hmore
    s_cmp_eq_u32 s62, 1
    s_cbranch_scc1 K2_nocarry
    v_accvgpr_read_b32 v8, a0
    v_accvgpr_read_b32 v9, a1
    v_accvgpr_read_b32 v10, a2
    v_accvgpr_read_b32 v11, a3
    v_accvgpr_read_b32 v12, a4
    v_accvgpr_read_b32 v13, a5
    v_accvgpr_read_b32 v14, a6
    v_accvgpr_read_b32 v15, a7
    v_pk_add_f32 v[0:1], v[0:1], v[8:9]
    v_pk_add_f32 v[2:3], v[2:3], v[10:11]
    v_pk_add_f32 v[4:5], v[4:5], v[12:13]
    v_pk_add_f32 v[6:7], v[6:7], v[14:15]
K2_nocarry:
    s_cmp_lg_u32 s61, 0
    s_cbranch_scc1 K2_next
    s_mov_b32 s64, 0x358637bd
    v_add_f32 v4, s64, v4
    v_add_f32 v5, s64, v5
    v_add_f32 v6, s64, v6
    v_add_f32 v7, s64, v7
    v_rcp_f32 v4, v4
    v_rcp_f32 v5, v5
    v_rcp_f32 v6, v6
    v_rcp_f32 v7, v7
    v_fma_f32 v0, v0, v4, v96
    v_fma_f32 v1, v1, v5, v97
    v_fma_f32 v2, v2, v6, v98
    v_fma_f32 v3, v3, v7, v99
    v_cmp_lt_f32 s[40:41], 0, v0
    v_cmp_lt_f32 s[42:43], 0, v1
    v_cmp_lt_f32 s[44:45], 0, v2
    v_cmp_lt_f32 s[46:47], 0, v3
    v_mul_f32 v4, 0, v0
    v_mul_f32 v5, 0, v1
    v_mul_f32 v6, 0, v2
    v_mul_f32 v7, 0, v3
    v_cndmask_b32 v0, v4, v0, s[40:41]
    v_cndmask_b32 v1, v5, v1, s[42:43]
    v_cndmask_b32 v2, v6, v2, s[44:45]
    v_cndmask_b32 v3, v7, v3, s[46:47]
    v_pk_add_f32 v[0:1], v[0:1], v[100:101]
    v_pk_add_f32 v[2:3], v[2:3], v[102:103]
    v_cvt_pk_bf16_f32 v4, v0, v1
    v_cvt_pk_bf16_f32 v5, v2, v3
    buffer_store_dwordx2 v[4:5], v107, s[24:27], 0 offen
K2_end:
    s_endpgm
K2_hmore:
    v_add_u32 v88, 256, v105
    v_and_b32 v89, 15, v91
    v_lshlrev_b32 v89, 4, v89
    v_add_u32 v89, 66048, v89
    v_cndmask_b32 v105, v89, v88, vcc
    v_max_u32 v106, 1, v106
    v_add_u32 v106, -1, v106
    s_branch K2_heads
K2_nowork:
    v_lshrrev_b32 v108, 4, v91
    v_lshlrev_b32 v109, 2, v108
    ds_read2st64_b32 v[110:111], v109 offset0:2 offset1:3
    v_and_b32 v105, 15, v91
    v_lshlrev_b32 v105, 4, v105
    v_add_u32 v105, 53504, v105
    v_lshl_add_u32 v104, v108, 8, v105
    ds_read_b128 v[96:99], v104 offset:16384
    v_bfe_u32 v107, v91, 5, 3
    v_bfe_u32 v109, v91, 1, 3
    v_xor_b32 v107, v107, v109
    v_lshlrev_b32 v107, 1, v107
    v_and_b32 v109, 1, v91
    v_add_lshl_u32 v107, v107, v109, 3
    v_lshl_add_u32 v107, v108, 7, v107
    v_add_u32 v107, 120064, v107
    ds_read_b64 v[102:103], v107
    s_mul_i32 s64, s2, 6272
    v_lshl_add_u32 v107, v91, 3, s64
    v_cmp_gt_u32 vcc, 49, v108
    s_waitcnt lgkmcnt(0)
    v_cndmask_b32 v106, 0, v111, vcc
    v_add_u32 v110, 50, v110
    v_cmp_lt_u32 vcc, 0, v106
    v_mov_b32 v109, 49
    v_lshlrev_b32 v100, 16, v102
    v_cndmask_b32 v109, v109, v110, vcc
    v_and_b32 v101, 0xffff0000, v102
    v_lshlrev_b32 v102, 16, v103
    v_and_b32 v103, 0xffff0000, v103
    v_lshl_add_u32 v105, v109, 8, v105
    s_branch K2_done
K2_shrink:
    v_mov_b32 v1, 0
    s_mov_b32 s31, 16
    s_mov_b64 s[48:49], 0
    s_mov_b64 s[50:51], 0
    s_mov_b64 s[52:53], 0
    s_mov_b64 s[54:55], 0
    s_branch K2_scan
K2_next:
    v_accvgpr_write_b32 a0, v0
    v_accvgpr_write_b32 a1, v1
    v_accvgpr_write_b32 a2, v2
    v_accvgpr_write_b32 a3, v3
    v_accvgpr_write_b32 a4, v4
    v_accvgpr_write_b32 a5, v5
    v_accvgpr_write_b32 a6, v6
    v_accvgpr_write_b32 a7, v7
    s_mov_b32 s62, 0
    s_add_u32 s29, s29, s31
    s_barrier
    v_mov_b32 v16, 0
    v_mov_b32 v17, 0
    v_mov_b32 v18, 0
    v_mov_b32 v19, 0
    v_lshlrev_b32 v20, 4, v91
    v_add_u32 v21, 86272, v20
    s_movk_i32 s64, 800
    v_cmp_gt_u32 vcc, s64, v91
    s_and_saveexec_b64 s[34:35], vcc
    ds_write_b128 v21, v[16:19]
    ds_write_b128 v21, v[16:19] offset:16896
    s_movk_i32 s64, 320
    v_cmp_gt_u32 vcc, s64, v91
    s_and_b64 exec, exec, vcc
    v_lshrrev_b32 v22, 6, v91
    v_cmp_eq_u32 vcc, 2, v22
    v_mov_b32 v23, 0xffff
    v_lshlrev_b32 v20, 2, v91
    v_cndmask_b32 v22, 0, v23, vcc
    ds_write_b32 v20, v22 offset:0
    s_mov_b64 exec, s[34:35]
    s_waitcnt vmcnt(0) lgkmcnt(0)
    s_barrier
    s_branch K2_recs
.section .rodata,"a"
.p2align 6
.amdhsa_kernel bin_kernel
  .amdhsa_next_free_vgpr 120
  .amdhsa_next_free_sgpr 48
  .amdhsa_accum_offset 120
  .amdhsa_group_segment_fixed_size 0
  .amdhsa_kernarg_size 96
  .amdhsa_user_sgpr_count 2
  .amdhsa_user_sgpr_kernarg_segment_ptr 1
  .amdhsa_system_sgpr_workgroup_id_x 1
  .amdhsa_dx10_clamp 0
.end_amdhsa_kernel
.p2align 6
.amdhsa_kernel standalone__edge_featured_mpnn_gatedgcn__graph_kernel
  .amdhsa_next_free_vgpr 128
  .amdhsa_next_free_sgpr 88
  .amdhsa_accum_offset 120
  .amdhsa_group_segment_fixed_size 0
  .amdhsa_kernarg_size 96
  .amdhsa_user_sgpr_count 2
  .amdhsa_user_sgpr_kernarg_segment_ptr 1
  .amdhsa_system_sgpr_workgroup_id_x 1
  .amdhsa_dx10_clamp 0
.end_amdhsa_kernel
```
